```python
import torch

def _softmax(x, axis=-1):
    return torch.softmax(x, dim=axis)
def _gelu(x):
    return torch.nn.functional.gelu(x, approximate="tanh")
def _silu(x):
    return torch.nn.functional.silu(x)
def _sigmoid(x):
    return torch.sigmoid(x)
def _layernorm(x, axis=-1, eps=1e-5):
    m = x.mean(dim=axis, keepdim=True)
    v = x.var(dim=axis, keepdim=True, unbiased=False)
    return (x - m) / torch.sqrt(v + eps)
def _scatter_add(tgt, idx, src, axis=0):
    return tgt.clone().index_add_(axis, idx, src)
def _segment_sum(src, seg, n):
    out = torch.zeros((n,) + src.shape[1:], dtype=src.dtype)
    return out.index_add_(0, seg, src)
def _pad(x, pw):
    flat = tuple(v for pair in reversed(pw) for v in pair)
    return torch.nn.functional.pad(x, flat)

kernel_name = 'parallel_sum__linear_kernel_hedgehog__glu_gated_reglu__prompt'

def setup_inputs():

    _w = (lambda a: (lambda t: t.to(torch.bfloat16) if t.is_floating_point() else t)(torch.as_tensor(a)))
    def _A_setup():
        B, S, D, H = 1, 2048, 512, 32
        Dh = D // H
        return {
            "x": _w((lambda *s: torch.randn(*s, dtype=torch.bfloat16) * 0.05)(B, S, D)),
            "wqkv": _w((lambda *s: torch.randn(*s, dtype=torch.bfloat16) * 0.2)(D, 3 * D)),
            "w_phi": _w((lambda *s: torch.randn(*s, dtype=torch.bfloat16) * 0.2)(H, Dh, Dh) * (Dh ** -0.5)),
            "wo": _w((lambda *s: torch.randn(*s, dtype=torch.bfloat16) * 0.05)(D, D)),
        }
    _A_in = _A_setup()

    def _B_setup():
        B, S, D, F = 1, 2048, 512, 1376
        return {
            "x": _w((lambda *s: torch.randn(*s, dtype=torch.bfloat16) * 0.05)(B, S, D)),
            "W_gate": _w((lambda *s: torch.randn(*s, dtype=torch.bfloat16) * 0.4)(D, F) * (2.0 / D) ** 0.5),
            "W_up": _w((lambda *s: torch.randn(*s, dtype=torch.bfloat16) * 0.4)(D, F) * (2.0 / D) ** 0.5),
            "W_down": _w((lambda *s: torch.randn(*s, dtype=torch.bfloat16) * 0.4)(F, D) * (1.0 / F) ** 0.5),
        }
    _B_in = _B_setup()

    return {
        "A_x": _A_in["x"],
        "A_wqkv": _A_in["wqkv"],
        "A_w_phi": _A_in["w_phi"],
        "A_wo": _A_in["wo"],
        "B_x": _B_in["x"],
        "B_W_gate": _B_in["W_gate"],
        "B_W_up": _B_in["W_up"],
        "B_W_down": _B_in["W_down"],
    }

def reference(A_x, A_wqkv, A_w_phi, A_wo, B_x, B_W_gate, B_W_up, B_W_down):
    def _A_ref(x, wqkv, w_phi, wo):
        B, S, D = x.shape
        H = 32; Dh = D // H
        qkv = (lambda x, *d: x.permute(*d))((x @ wqkv).reshape(B, S, 3, H, Dh), 2, 0, 3, 1, 4)
        q, k, v = qkv[0], qkv[1], qkv[2]
        pq = torch.einsum("bhsd,hdf->bhsf", q, w_phi)
        pk = torch.einsum("bhsd,hdf->bhsf", k, w_phi)
        phi_q = torch.concatenate([_softmax(pq, axis=-1), _softmax(-pq, axis=-1)], axis=-1)
        phi_k = torch.concatenate([_softmax(pk, axis=-1), _softmax(-pk, axis=-1)], axis=-1)
        kv = torch.einsum("bhsf,bhsd->bhfd", phi_k, v)
        z  = torch.einsum("bhsf->bhf", phi_k)
        num = torch.einsum("bhqf,bhfd->bhqd", phi_q, kv)
        den = torch.einsum("bhqf,bhf->bhq", phi_q, z)[..., None] + 1e-6
        o = num / den
        return (lambda x, *d: x.permute(*d))(o, 0, 2, 1, 3).reshape(B, S, D) @ wo

    def _B_ref(x, W_gate, W_up, W_down):
        gate = torch.einsum("bsd,df->bsf", x, W_gate)
        up = torch.einsum("bsd,df->bsf", x, W_up)
        gate = gate * (lambda x, dt: x.to(dt))(gate > 0, gate.dtype)
        h = gate * up
        return torch.einsum("bsf,fd->bsd", h, W_down)

    x = A_x
    xn = _layernorm(x, axis=-1)
    return x + _A_ref(xn, A_wqkv, A_w_phi, A_wo) + _B_ref(xn, B_W_gate, B_W_up, B_W_down)
```

```asm
; @launch grid=(256,1,1) block=(512,1,1) lds=163840
.amdgcn_target "amdgcn-amd-amdhsa--gfx950"
.text
.globl parallel_sum__linear_kernel_hedgehog__glu_gated_reglu__prompt_kernel
.p2align 8
.type parallel_sum__linear_kernel_hedgehog__glu_gated_reglu__prompt_kernel,@function
parallel_sum__linear_kernel_hedgehog__glu_gated_reglu__prompt_kernel:
  s_cmp_ge_u32 s2, 256
  s_cbranch_scc1 L_end
  s_load_dwordx16 s[8:23], s[0:1], 0
  s_load_dwordx4 s[24:27], s[0:1], 64
  s_load_dwordx2 s[28:29], s[0:1], 80
  v_lshrrev_b32 v21, 6, v0
  v_and_b32 v1, 63, v0
  v_readfirstlane_b32 s54, v21
  s_and_b32 s69, s2, 7
  s_lshr_b32 s70, s2, 3
  s_and_b32 s59, s69, 1
  s_lshr_b32 s61, s69, 1
  s_and_b32 s58, s70, 7
  s_lshr_b32 s60, s70, 3
  s_lshl_b32 s57, s59, 3
  s_add_u32 s57, s57, s58
  v_lshrrev_b32 v21, 3, v1
  s_lshl_b32 s71, s54, 3
  v_add_u32 v21, s71, v21
  v_lshrrev_b32 v22, 1, v21
  v_xor_b32 v22, v22, v1
  v_and_b32 v22, 7, v22
  v_lshlrev_b32 v22, 4, v22
  v_lshlrev_b32 v21, 10, v21
  v_add_u32 v3, v21, v22
  v_add_u32 v4, 65536, v3
  s_lshl_b32 s71, s61, 1
  s_and_b32 s72, s60, 1
  s_add_u32 s71, s71, s72
  s_add_u32 s100, s58, s71
  s_and_b32 s100, s100, 7
  s_lshr_b32 s72, s60, 1
  s_xor_b32 s101, s59, s72
  s_lshl_b32 s69, s100, 2
  s_lshl_b32 s70, 1, s69
  s_sub_u32 s70, s70, 1
  s_and_b32 s71, s70, 0x76543210
  s_andn2_b32 s71, s71, 15
  s_lshl_b32 s71, s71, 4
  s_lshl_b32 s70, s70, 4
  s_or_b32 s70, s70, 15
  s_andn2_b32 s72, 0x76543210, s70
  s_or_b32 s63, s71, s72
  s_lshl_b32 s69, s100, 4
  s_or_b32 s63, s63, s69
  s_cmp_eq_u32 s100, 0
  s_cselect_b32 s63, 0x76543201, s63
  s_lshl_b32 s66, s57, 17
  s_lshl_b32 s78, s54, 10
  s_cmp_ge_u32 s60, 2
  s_cbranch_scc1 L_ffn
  s_lshl_b32 s82, s61, 1
  s_add_u32 s82, s82, s60
  s_mov_b32 s81, s82
  v_lshrrev_b32 v21, 3, v1
  s_lshl_b32 s69, s54, 3
  v_add_u32 v21, s69, v21
  v_bfe_u32 v22, v21, 1, 1
  v_lshlrev_b32 v22, 2, v22
  v_and_b32 v23, 7, v1
  v_xor_b32 v22, v22, v23
  v_lshlrev_b32 v22, 4, v22
  v_mul_u32_u24 v21, 3072, v21
  v_add_u32 v7, v21, v22
  v_add_u32 v5, 1024, v7
  v_add_u32 v6, 2048, v7
  s_lshl_b32 s96, s82, 7
  s_waitcnt lgkmcnt(0)
  s_mov_b32 s32, s8
  s_and_b32 s33, s9, 0xffff
  s_mov_b32 s34, 2097152
  s_mov_b32 s35, 0x20000
  s_mov_b32 s36, s10
  s_and_b32 s37, s11, 0xffff
  s_mov_b32 s38, 1572864
  s_mov_b32 s39, 0x20000
  s_bfe_u32 s88, s63, 262144
  s_lshl_b32 s88, s88, 7
  s_add_u32 s88, s88, s66
  s_add_u32 m0, s78, 65536
  s_nop 0
  buffer_load_dwordx4 v3, s[32:35], s88 offen lds
  s_add_u32 m0, s78, 73728
  s_nop 0
  buffer_load_dwordx4 v4, s[32:35], s88 offen lds
  s_bfe_u32 s89, s63, 262144
  s_mul_i32 s89, s89, 196608
  s_add_u32 s89, s89, s96
  s_add_u32 m0, s78, 81920
  s_nop 0
  buffer_load_dwordx4 v5, s[36:39], s89 offen lds
  s_add_u32 m0, s78, 90112
  s_nop 0
  buffer_load_dwordx4 v6, s[36:39], s89 offen lds
  s_mov_b32 s48, s28
  s_and_b32 s49, s29, 0xffff
  s_mov_b32 s50, 9437184
  s_mov_b32 s51, 0x20000
  v_mov_b32 v2, 0
  s_and_b32 s55, s54, 3
  s_lshr_b32 s56, s54, 2
  s_and_b32 s69, s2, 7
  s_lshr_b32 s70, s2, 3
  s_and_b32 s85, s70, 7
  s_lshr_b32 s71, s70, 3
  s_lshl_b32 s86, s69, 3
  s_lshl_b32 s71, s71, 1
  s_add_u32 s86, s86, s71
  s_lshr_b32 s84, s86, 2
  s_add_u32 s86, s86, s56
  s_mul_i32 s87, s55, 22
  s_cmp_eq_u32 s55, 3
  s_cselect_b32 s69, 1, 0
  s_sub_u32 s87, s87, s69
  v_lshrrev_b32 v21, 3, v1
  s_lshl_b32 s69, s56, 3
  v_add_u32 v21, s69, v21
  v_bfe_u32 v22, v21, 1, 1
  v_lshlrev_b32 v22, 2, v22
  v_and_b32 v23, 7, v1
  v_xor_b32 v22, v22, v23
  v_lshlrev_b32 v22, 4, v22
  v_lshlrev_b32 v21, 10, v21
  v_add_u32 v21, v21, v22
  s_lshl_b32 s69, s85, 7
  v_add_u32 v27, s69, v21
  s_mul_i32 s3, s85, 11
  s_lshr_b32 s3, s3, 2
  s_cmp_ge_u32 s55, 2
  s_cselect_b32 s4, 21, 22
  s_mov_b32 s5, s85
  v_lshrrev_b32 v21, 5, v1
  v_lshlrev_b32 v21, 7, v21
  v_and_b32 v22, 15, v1
  v_lshlrev_b32 v22, 1, v22
  v_add_u32 v21, v21, v22
  s_lshl_b32 s69, s82, 2
  s_lshl_b32 s70, s56, 1
  s_add_u32 s69, s69, s70
  s_lshl_b32 s69, s69, 9
  v_add_u32 v21, s69, v21
  global_load_ushort v120, v21, s[12:13] offset:0
  global_load_ushort v121, v21, s[12:13] offset:32
  global_load_ushort v122, v21, s[12:13] offset:64
  global_load_ushort v123, v21, s[12:13] offset:96
  global_load_ushort v124, v21, s[12:13] offset:256
  global_load_ushort v125, v21, s[12:13] offset:288
  global_load_ushort v126, v21, s[12:13] offset:320
  global_load_ushort v127, v21, s[12:13] offset:352
  global_load_ushort v128, v21, s[12:13] offset:512
  global_load_ushort v129, v21, s[12:13] offset:544
  global_load_ushort v130, v21, s[12:13] offset:576
  global_load_ushort v131, v21, s[12:13] offset:608
  global_load_ushort v132, v21, s[12:13] offset:768
  global_load_ushort v133, v21, s[12:13] offset:800
  global_load_ushort v134, v21, s[12:13] offset:832
  global_load_ushort v135, v21, s[12:13] offset:864
  s_bfe_u32 s88, s63, 262148
  s_lshl_b32 s88, s88, 7
  s_add_u32 s88, s88, s66
  s_add_u32 m0, s78, 98304
  s_nop 0
  buffer_load_dwordx4 v3, s[32:35], s88 offen lds
  s_add_u32 m0, s78, 106496
  s_nop 0
  buffer_load_dwordx4 v4, s[32:35], s88 offen lds
  s_bfe_u32 s89, s63, 262148
  s_mul_i32 s89, s89, 196608
  s_add_u32 s89, s89, s96
  s_add_u32 m0, s78, 114688
  s_nop 0
  buffer_load_dwordx4 v5, s[36:39], s89 offen lds
  s_add_u32 m0, s78, 122880
  s_nop 0
  buffer_load_dwordx4 v6, s[36:39], s89 offen lds
  s_bfe_u32 s90, s63, 262148
  s_mul_i32 s90, s90, 196608
  s_add_u32 s90, s90, s96
  s_add_u32 m0, s78, 32768
  s_nop 0
  buffer_load_dwordx4 v7, s[36:39], s90 offen lds
  v_and_b32 v21, 31, v1
  s_lshl_b32 s69, s55, 5
  v_add_u32 v21, s69, v21
  v_lshrrev_b32 v22, 1, v21
  v_and_b32 v22, 7, v22
  v_lshrrev_b32 v23, 5, v1
  v_xor_b32 v22, v22, v23
  v_lshlrev_b32 v22, 4, v22
  v_lshlrev_b32 v21, 7, v21
  v_add_u32 v21, v21, v22
  s_lshl_b32 s69, s101, 6
  v_xor_b32 v21, s69, v21
  v_xor_b32 v8, 0, v21
  v_xor_b32 v9, 32, v21
  v_xor_b32 v10, 64, v21
  v_xor_b32 v11, 96, v21
  v_lshrrev_b32 v21, 5, v1
  v_lshlrev_b32 v21, 3, v21
  v_bfe_u32 v23, v1, 2, 2
  v_add_u32 v21, v21, v23
  v_lshlrev_b32 v21, 7, v21
  v_lshrrev_b32 v23, 1, v23
  v_xor_b32 v23, s56, v23
  v_lshlrev_b32 v23, 6, v23
  v_add_u32 v21, v21, v23
  v_bfe_u32 v23, v1, 4, 1
  v_lshlrev_b32 v23, 5, v23
  v_add_u32 v21, v21, v23
  v_and_b32 v23, 3, v1
  v_lshlrev_b32 v23, 3, v23
  v_add_u32 v21, v21, v23
  s_lshl_b32 s69, s101, 12
  v_add_u32 v16, s69, v21
  s_sub_u32 s69, 4096, s69
  v_add_u32 v17, s69, v21
  v_and_b32 v21, 31, v1
  s_lshl_b32 s69, s55, 5
  v_add_u32 v21, s69, v21
  v_lshrrev_b32 v22, 5, v1
  v_bfe_u32 v23, v21, 1, 3
  v_xor_b32 v23, v23, v22
  v_lshlrev_b32 v23, 3, v23
  v_lshlrev_b32 v12, 6, v21
  v_add_u32 v12, v12, v23
  s_lshl_b32 s69, s56, 14
  s_add_u32 s69, s69, 112640
  v_add_u32 v12, s69, v12
  v_xor_b32 v13, 16, v12
  v_xor_b32 v14, 32, v12
  v_xor_b32 v15, 48, v12
  v_bfe_u32 v23, v21, 2, 2
  v_xor_b32 v23, v23, v22
  v_lshlrev_b32 v23, 3, v23
  v_lshlrev_b32 v18, 5, v21
  v_add_u32 v18, v18, v23
  s_lshl_b32 s69, s56, 13
  s_add_u32 s69, s69, 145408
  v_add_u32 v18, s69, v18
  v_xor_b32 v19, 16, v18
  v_lshrrev_b32 v28, 5, v1
  v_bfe_u32 v29, v1, 2, 2
  v_bfe_u32 v30, v1, 4, 1
  v_and_b32 v31, 3, v1
  v_lshlrev_b32 v21, 3, v28
  v_add_u32 v21, v21, v29
  v_lshlrev_b32 v22, 2, v30
  v_add_u32 v22, v22, v31
  v_bfe_u32 v23, v21, 1, 3
  v_xor_b32 v22, v22, v23
  v_lshlrev_b32 v22, 3, v22
  v_lshlrev_b32 v23, 6, v21
  v_add_u32 v22, v22, v23
  s_lshl_b32 s69, s55, 13
  s_add_u32 s69, s69, 112640
  v_add_u32 v216, s69, v22
  v_xor_b32 v217, 16, v216
  v_add_u32 v217, 256, v217
  v_bfe_u32 v23, v21, 2, 2
  v_xor_b32 v23, v23, v31
  v_lshlrev_b32 v23, 3, v23
  v_lshlrev_b32 v22, 5, v21
  v_add_u32 v22, v22, v23
  s_lshl_b32 s69, s55, 12
  s_add_u32 s69, s69, 145408
  v_add_u32 v218, s69, v22
  v_xor_b32 v219, 8, v218
  v_add_u32 v219, 128, v219
  v_and_b32 v22, 15, v1
  v_lshlrev_b32 v22, 3, v22
  v_add_u32 v22, 108544, v22
  v_cmp_eq_u32 vcc, 1, v30
  s_nop 1
  v_cndmask_b32 v218, v218, v22, vcc
  v_cndmask_b32 v219, v219, v22, vcc
  v_mov_b32 v23, 512
  v_cndmask_b32 v220, v23, v2, vcc
  s_mul_i32 s67, s81, 1408
  s_mul_i32 s70, s56, 384
  s_add_u32 s67, s67, s70
  s_add_u32 s67, s67, 8458240
  s_lshl_b32 s70, s55, 7
  s_add_u32 s68, s67, s70
  s_lshl_b32 s70, s57, 2
  s_add_u32 s70, s70, s55
  s_lshl_b32 s71, s70, 7
  s_add_u32 s62, s71, 8480768
  s_lshl_b32 s71, s81, 7
  s_add_u32 s91, s71, 8497152
  s_lshl_b32 s71, s57, 7
  s_add_u32 s92, s71, 8500224
  s_lshl_b32 s69, s82, 2
  s_add_u32 s71, s69, s55
  s_mul_i32 s93, s71, 2176
  s_add_u32 s93, s93, 8388608
  s_lshl_b32 s71, s56, 1
  s_add_u32 s71, s71, s69
  s_mul_i32 s94, s71, 2176
  s_add_u32 s94, s94, 8388608
  s_lshl_b32 s70, s70, 5
  s_add_u32 s70, s70, s71
  s_lshl_b32 s70, s70, 10
  s_add_u32 s95, s70, 6291456
  v_mov_b32 v160, 0
  v_mov_b32 v161, 0
  v_mov_b32 v162, 0
  v_mov_b32 v163, 0
  v_mov_b32 v164, 0
  v_mov_b32 v165, 0
  v_mov_b32 v166, 0
  v_mov_b32 v167, 0
  v_mov_b32 v168, 0
  v_mov_b32 v169, 0
  v_mov_b32 v170, 0
  v_mov_b32 v171, 0
  v_mov_b32 v172, 0
  v_mov_b32 v173, 0
  v_mov_b32 v174, 0
  v_mov_b32 v175, 0
  v_mov_b32 v176, 0
  v_mov_b32 v177, 0
  v_mov_b32 v178, 0
  v_mov_b32 v179, 0
  v_mov_b32 v180, 0
  v_mov_b32 v181, 0
  v_mov_b32 v182, 0
  v_mov_b32 v183, 0
  v_mov_b32 v184, 0
  v_mov_b32 v185, 0
  v_mov_b32 v186, 0
  v_mov_b32 v187, 0
  v_mov_b32 v188, 0
  v_mov_b32 v189, 0
  v_mov_b32 v190, 0
  v_mov_b32 v191, 0
  v_mov_b32 v240, 0x3f803f80
  v_mov_b32 v241, 0x3f803f80
  v_mov_b32 v242, 0x3f803f80
  v_mov_b32 v243, 0x3f803f80
  v_mov_b32 v20, 0
  v_mov_b32 v29, 0
  s_waitcnt vmcnt(5)
  s_barrier
  s_bfe_u32 s88, s63, 262152
  s_lshl_b32 s88, s88, 7
  s_add_u32 s88, s88, s66
  s_add_u32 m0, s78, 131072
  s_nop 0
  buffer_load_dwordx4 v3, s[32:35], s88 offen lds
  s_add_u32 m0, s78, 139264
  s_nop 0
  buffer_load_dwordx4 v4, s[32:35], s88 offen lds
  s_bfe_u32 s89, s63, 262152
  s_mul_i32 s89, s89, 196608
  s_add_u32 s89, s89, s96
  s_add_u32 m0, s78, 147456
  s_nop 0
  buffer_load_dwordx4 v5, s[36:39], s89 offen lds
  s_add_u32 m0, s78, 155648
  s_nop 0
  buffer_load_dwordx4 v6, s[36:39], s89 offen lds
  s_bfe_u32 s88, s63, 262156
  s_lshl_b32 s88, s88, 7
  s_add_u32 s88, s88, s66
  s_add_u32 m0, s78, 0
  s_nop 0
  buffer_load_dwordx4 v3, s[32:35], s88 offen lds
  s_add_u32 m0, s78, 8192
  s_nop 0
  buffer_load_dwordx4 v4, s[32:35], s88 offen lds
  s_bfe_u32 s89, s63, 262156
  s_mul_i32 s89, s89, 196608
  s_add_u32 s89, s89, s96
  s_add_u32 m0, s78, 16384
  s_nop 0
  buffer_load_dwordx4 v5, s[36:39], s89 offen lds
  s_add_u32 m0, s78, 24576
  s_nop 0
  buffer_load_dwordx4 v6, s[36:39], s89 offen lds
  v_bfe_u32 v23, v1, 4, 1
  s_mov_b32 s69, 0x80008000
  v_mul_lo_u32 v23, s69, v23
  v_lshl_or_b32 v224, v121, 16, v120
  v_xor_b32 v224, v23, v224
  v_lshl_or_b32 v225, v123, 16, v122
  v_xor_b32 v225, v23, v225
  v_lshl_or_b32 v226, v125, 16, v124
  v_xor_b32 v226, v23, v226
  v_lshl_or_b32 v227, v127, 16, v126
  v_xor_b32 v227, v23, v227
  v_lshl_or_b32 v228, v129, 16, v128
  v_xor_b32 v228, v23, v228
  v_lshl_or_b32 v229, v131, 16, v130
  v_xor_b32 v229, v23, v229
  v_lshl_or_b32 v230, v133, 16, v132
  v_xor_b32 v230, v23, v230
  v_lshl_or_b32 v231, v135, 16, v134
  v_xor_b32 v231, v23, v231
  v_add_u32 v221, 65536, v16
  v_add_u32 v222, 131072, v16
  v_add_u32 v223, 65536, v17
  v_add_u32 v28, 131072, v17
  ds_read_b64_tr_b16 v[192:193], v221 offset:16384
  ds_read_b64_tr_b16 v[194:195], v221 offset:16896
  ds_read_b64_tr_b16 v[196:197], v221 offset:24576
  ds_read_b64_tr_b16 v[198:199], v221 offset:25088
  v_add_u32 v21, 65536, v8
  ds_read_b128 v[32:35], v21 offset:0
  ds_read_b64_tr_b16 v[200:201], v221 offset:18432
  ds_read_b64_tr_b16 v[202:203], v221 offset:18944
  ds_read_b64_tr_b16 v[204:205], v221 offset:26624
  ds_read_b64_tr_b16 v[206:207], v221 offset:27136
  v_add_u32 v22, 65536, v9
  ds_read_b128 v[36:39], v22 offset:0
  s_waitcnt lgkmcnt(5)
  v_mfma_f32_32x32x16_bf16 v[160:175], v[192:195], v[32:35], v[160:175]
  ds_read_b64_tr_b16 v[192:193], v223 offset:16384
  ds_read_b64_tr_b16 v[194:195], v223 offset:16896
  v_mfma_f32_32x32x16_bf16 v[176:191], v[196:199], v[32:35], v[176:191]
  ds_read_b64_tr_b16 v[196:197], v223 offset:24576
  ds_read_b64_tr_b16 v[198:199], v223 offset:25088
  v_add_u32 v21, 65536, v10
  ds_read_b128 v[40:43], v21 offset:0
  s_waitcnt lgkmcnt(5)
  v_mfma_f32_32x32x16_bf16 v[160:175], v[200:203], v[36:39], v[160:175]
  ds_read_b64_tr_b16 v[200:201], v223 offset:18432
  ds_read_b64_tr_b16 v[202:203], v223 offset:18944
  v_mfma_f32_32x32x16_bf16 v[176:191], v[204:207], v[36:39], v[176:191]
  ds_read_b64_tr_b16 v[204:205], v223 offset:26624
  ds_read_b64_tr_b16 v[206:207], v223 offset:27136
  v_add_u32 v22, 65536, v11
  ds_read_b128 v[44:47], v22 offset:0
  s_waitcnt vmcnt(8) lgkmcnt(5)
  s_barrier
  v_mfma_f32_32x32x16_bf16 v[160:175], v[192:195], v[40:43], v[160:175]
  ds_read_b64_tr_b16 v[192:193], v221 offset:49152
  ds_read_b64_tr_b16 v[194:195], v221 offset:49664
  v_mfma_f32_32x32x16_bf16 v[176:191], v[196:199], v[40:43], v[176:191]
  ds_read_b64_tr_b16 v[196:197], v221 offset:57344
  ds_read_b64_tr_b16 v[198:199], v221 offset:57856
  v_add_u32 v21, 65536, v8
  ds_read_b128 v[48:51], v21 offset:32768
  s_waitcnt lgkmcnt(5)
  v_mfma_f32_32x32x16_bf16 v[160:175], v[200:203], v[44:47], v[160:175]
  ds_read_b64_tr_b16 v[200:201], v221 offset:51200
  ds_read_b64_tr_b16 v[202:203], v221 offset:51712
  s_cmp_eq_u32 s55, 2
  s_cbranch_scc0 L_csq_1
  ds_read_b64_tr_b16 v[136:137], v16 offset:32768
  ds_read_b64_tr_b16 v[138:139], v16 offset:33280
  ds_read_b64_tr_b16 v[140:141], v16 offset:34816
  ds_read_b64_tr_b16 v[142:143], v16 offset:35328
L_csq_1:
  v_mfma_f32_32x32x16_bf16 v[176:191], v[204:207], v[44:47], v[176:191]
  ds_read_b64_tr_b16 v[204:205], v221 offset:59392
  ds_read_b64_tr_b16 v[206:207], v221 offset:59904
  global_load_dword v25, v2, s[26:27] sc1
  v_add_u32 v22, 65536, v9
  ds_read_b128 v[52:55], v22 offset:32768
  s_waitcnt lgkmcnt(5)
  v_mfma_f32_32x32x16_bf16 v[160:175], v[192:195], v[48:51], v[160:175]
  s_cmp_eq_u32 s55, 0
  s_cbranch_scc0 L_cs_2
  v_mfma_f32_32x32x16_bf16 v[144:159], v[240:243], v[192:195], 0
L_cs_2:
  ds_read_b64_tr_b16 v[192:193], v223 offset:49152
  ds_read_b64_tr_b16 v[194:195], v223 offset:49664
  v_dot2c_f32_bf16 v20, v48, v240
  v_dot2c_f32_bf16 v20, v49, v240
  v_dot2c_f32_bf16 v20, v50, v240
  v_dot2c_f32_bf16 v20, v51, v240
  v_dot2c_f32_bf16 v29, v48, v48
  v_dot2c_f32_bf16 v29, v49, v49
  v_dot2c_f32_bf16 v29, v50, v50
  v_dot2c_f32_bf16 v29, v51, v51
  v_mfma_f32_32x32x16_bf16 v[176:191], v[196:199], v[48:51], v[176:191]
  s_cmp_eq_u32 s55, 1
  s_cbranch_scc0 L_cs_3
  v_mfma_f32_32x32x16_bf16 v[144:159], v[240:243], v[196:199], 0
L_cs_3:
  ds_read_b64_tr_b16 v[196:197], v223 offset:57344
  ds_read_b64_tr_b16 v[198:199], v223 offset:57856
  v_add_u32 v21, 65536, v10
  ds_read_b128 v[56:59], v21 offset:32768
  s_waitcnt lgkmcnt(5)
  v_mfma_f32_32x32x16_bf16 v[160:175], v[200:203], v[52:55], v[160:175]
  s_cmp_eq_u32 s55, 0
  s_cbranch_scc0 L_cs_4
  v_mfma_f32_32x32x16_bf16 v[144:159], v[240:243], v[200:203], v[144:159]
L_cs_4:
  ds_read_b64_tr_b16 v[200:201], v223 offset:51200
  ds_read_b64_tr_b16 v[202:203], v223 offset:51712
  v_dot2c_f32_bf16 v20, v52, v240
  v_dot2c_f32_bf16 v20, v53, v240
  v_dot2c_f32_bf16 v20, v54, v240
  v_dot2c_f32_bf16 v20, v55, v240
  v_dot2c_f32_bf16 v29, v52, v52
  v_dot2c_f32_bf16 v29, v53, v53
  v_dot2c_f32_bf16 v29, v54, v54
  v_dot2c_f32_bf16 v29, v55, v55
  v_mfma_f32_32x32x16_bf16 v[176:191], v[204:207], v[52:55], v[176:191]
  s_cmp_eq_u32 s55, 1
  s_cbranch_scc0 L_cs_5
  v_mfma_f32_32x32x16_bf16 v[144:159], v[240:243], v[204:207], v[144:159]
L_cs_5:
  ds_read_b64_tr_b16 v[204:205], v223 offset:59392
  ds_read_b64_tr_b16 v[206:207], v223 offset:59904
  v_add_u32 v22, 65536, v11
  ds_read_b128 v[60:63], v22 offset:32768
  s_waitcnt vmcnt(5) lgkmcnt(5)
  s_barrier
  v_mfma_f32_32x32x16_bf16 v[160:175], v[192:195], v[56:59], v[160:175]
  ds_read_b64_tr_b16 v[192:193], v222 offset:16384
  ds_read_b64_tr_b16 v[194:195], v222 offset:16896
  s_bfe_u32 s88, s63, 262160
  s_lshl_b32 s88, s88, 7
  s_add_u32 s88, s88, s66
  s_add_u32 m0, s78, 32768
  s_nop 0
  buffer_load_dwordx4 v3, s[32:35], s88 offen lds
  s_add_u32 m0, s78, 40960
  s_nop 0
  buffer_load_dwordx4 v4, s[32:35], s88 offen lds
  v_mfma_f32_32x32x16_bf16 v[176:191], v[196:199], v[56:59], v[176:191]
  ds_read_b64_tr_b16 v[196:197], v222 offset:24576
  ds_read_b64_tr_b16 v[198:199], v222 offset:25088
  v_dot2c_f32_bf16 v20, v56, v240
  v_dot2c_f32_bf16 v20, v57, v240
  v_dot2c_f32_bf16 v20, v58, v240
  v_dot2c_f32_bf16 v20, v59, v240
  v_dot2c_f32_bf16 v29, v56, v56
  v_dot2c_f32_bf16 v29, v57, v57
  v_dot2c_f32_bf16 v29, v58, v58
  v_dot2c_f32_bf16 v29, v59, v59
  v_add_u32 v21, 131072, v8
  ds_read_b128 v[64:67], v21 offset:0
  s_waitcnt lgkmcnt(5)
  v_mfma_f32_32x32x16_bf16 v[160:175], v[200:203], v[60:63], v[160:175]
  ds_read_b64_tr_b16 v[200:201], v222 offset:18432
  ds_read_b64_tr_b16 v[202:203], v222 offset:18944
  s_bfe_u32 s89, s63, 262160
  s_mul_i32 s89, s89, 196608
  s_add_u32 s89, s89, s96
  s_add_u32 m0, s78, 49152
  s_nop 0
  buffer_load_dwordx4 v5, s[36:39], s89 offen lds
  s_add_u32 m0, s78, 57344
  s_nop 0
  buffer_load_dwordx4 v6, s[36:39], s89 offen lds
  v_mfma_f32_32x32x16_bf16 v[176:191], v[204:207], v[60:63], v[176:191]
  ds_read_b64_tr_b16 v[204:205], v222 offset:26624
  ds_read_b64_tr_b16 v[206:207], v222 offset:27136
  v_dot2c_f32_bf16 v20, v60, v240
  v_dot2c_f32_bf16 v20, v61, v240
  v_dot2c_f32_bf16 v20, v62, v240
  v_dot2c_f32_bf16 v20, v63, v240
  v_dot2c_f32_bf16 v29, v60, v60
  v_dot2c_f32_bf16 v29, v61, v61
  v_dot2c_f32_bf16 v29, v62, v62
  v_dot2c_f32_bf16 v29, v63, v63
  v_add_u32 v22, 131072, v9
  ds_read_b128 v[68:71], v22 offset:0
  s_waitcnt lgkmcnt(5)
  v_mfma_f32_32x32x16_bf16 v[160:175], v[192:195], v[64:67], v[160:175]
  ds_read_b64_tr_b16 v[192:193], v28 offset:16384
  ds_read_b64_tr_b16 v[194:195], v28 offset:16896
  s_waitcnt vmcnt(4)
  v_readfirstlane_b32 s69, v25
  s_nop 1
  s_cmp_lt_u32 s69, 32
  s_cbranch_scc1 L_slow_ini_a
L_back_ini_a:
  s_bfe_u32 s88, s63, 262164
  s_lshl_b32 s88, s88, 7
  s_add_u32 s88, s88, s66
  s_add_u32 m0, s78, 65536
  s_nop 0
  buffer_load_dwordx4 v3, s[32:35], s88 offen lds
  v_mfma_f32_32x32x16_bf16 v[176:191], v[196:199], v[64:67], v[176:191]
  ds_read_b64_tr_b16 v[196:197], v28 offset:24576
  ds_read_b64_tr_b16 v[198:199], v28 offset:25088
  s_add_u32 m0, s78, 73728
  s_nop 0
  buffer_load_dwordx4 v4, s[32:35], s88 offen lds
  s_cmp_eq_u32 s55, 2
  s_cbranch_scc0 L_csq_6
  v_mfma_f32_32x32x16_bf16 v[144:159], v[240:243], v[136:139], 0
  v_mfma_f32_32x32x16_bf16 v[144:159], v[240:243], v[140:143], v[144:159]
L_csq_6:
  v_add_u32 v21, 131072, v10
  ds_read_b128 v[72:75], v21 offset:0
  s_waitcnt lgkmcnt(5)
  v_mfma_f32_32x32x16_bf16 v[160:175], v[200:203], v[68:71], v[160:175]
  ds_read_b64_tr_b16 v[200:201], v28 offset:18432
  ds_read_b64_tr_b16 v[202:203], v28 offset:18944
  s_cmp_eq_u32 s56, 1
  s_cselect_b64 vcc, -1, 0
  v_cndmask_b32 v20, v20, v29, vcc
  v_mov_b32 v30, v20
  s_lshl_b32 s70, s56, 13
  s_nop 0
  v_permlane32_swap_b32 v30, v20
  v_add_f32 v30, v30, v20
  s_bfe_u32 s89, s63, 262164
  s_mul_i32 s89, s89, 196608
  s_add_u32 s89, s89, s96
  s_add_u32 m0, s78, 81920
  s_nop 0
  buffer_load_dwordx4 v5, s[36:39], s89 offen lds
  v_mfma_f32_32x32x16_bf16 v[176:191], v[204:207], v[68:71], v[176:191]
  ds_read_b64_tr_b16 v[204:205], v28 offset:26624
  ds_read_b64_tr_b16 v[206:207], v28 offset:27136
  s_add_u32 m0, s78, 90112
  s_nop 0
  buffer_load_dwordx4 v6, s[36:39], s89 offen lds
  v_add_u32 v22, 131072, v11
  ds_read_b128 v[76:79], v22 offset:0
  s_waitcnt vmcnt(9) lgkmcnt(5)
  s_barrier
  v_mfma_f32_32x32x16_bf16 v[160:175], v[192:195], v[72:75], v[160:175]
  ds_read_b64_tr_b16 v[192:193], v16 offset:16384
  ds_read_b64_tr_b16 v[194:195], v16 offset:16896
  s_lshl_b32 s70, s56, 13
  s_add_u32 s70, s70, s62
  v_lshlrev_b32 v23, 2, v1
  s_mov_b32 exec_hi, 0
  buffer_atomic_add_f32 v30, v23, s[48:51], s70 offen
  s_cmp_lt_u32 s55, 3
  s_cbranch_scc0 L_pub_7
  buffer_atomic_add_f32 v144, v23, s[48:51], s68 offen
L_pub_7:
  s_mov_b32 exec_hi, -1
  v_mfma_f32_32x32x16_bf16 v[176:191], v[196:199], v[72:75], v[176:191]
  ds_read_b64_tr_b16 v[196:197], v16 offset:24576
  ds_read_b64_tr_b16 v[198:199], v16 offset:25088
  s_bfe_u32 s88, s63, 262168
  s_lshl_b32 s88, s88, 7
  s_add_u32 s88, s88, s66
  s_add_u32 m0, s78, 98304
  s_nop 0
  buffer_load_dwordx4 v3, s[32:35], s88 offen lds
  ds_read_b128 v[80:83], v8 offset:0
  s_waitcnt lgkmcnt(5)
  v_mfma_f32_32x32x16_bf16 v[160:175], v[200:203], v[76:79], v[160:175]
  ds_read_b64_tr_b16 v[200:201], v16 offset:18432
  ds_read_b64_tr_b16 v[202:203], v16 offset:18944
  s_add_u32 m0, s78, 106496
  s_nop 0
  buffer_load_dwordx4 v4, s[32:35], s88 offen lds
  v_mfma_f32_32x32x16_bf16 v[176:191], v[204:207], v[76:79], v[176:191]
  ds_read_b64_tr_b16 v[204:205], v16 offset:26624
  ds_read_b64_tr_b16 v[206:207], v16 offset:27136
  ds_read_b128 v[84:87], v9 offset:0
  s_waitcnt lgkmcnt(5)
  v_mfma_f32_32x32x16_bf16 v[160:175], v[192:195], v[80:83], v[160:175]
  ds_read_b64_tr_b16 v[192:193], v17 offset:16384
  ds_read_b64_tr_b16 v[194:195], v17 offset:16896
  s_bfe_u32 s89, s63, 262168
  s_mul_i32 s89, s89, 196608
  s_add_u32 s89, s89, s96
  s_add_u32 m0, s78, 114688
  s_nop 0
  buffer_load_dwordx4 v5, s[36:39], s89 offen lds
  v_mfma_f32_32x32x16_bf16 v[176:191], v[196:199], v[80:83], v[176:191]
  ds_read_b64_tr_b16 v[196:197], v17 offset:24576
  ds_read_b64_tr_b16 v[198:199], v17 offset:25088
  ds_read_b128 v[88:91], v10 offset:0
  s_waitcnt lgkmcnt(5)
  v_mfma_f32_32x32x16_bf16 v[160:175], v[200:203], v[84:87], v[160:175]
  ds_read_b64_tr_b16 v[200:201], v17 offset:18432
  ds_read_b64_tr_b16 v[202:203], v17 offset:18944
  s_add_u32 m0, s78, 122880
  s_nop 0
  buffer_load_dwordx4 v6, s[36:39], s89 offen lds
  v_mfma_f32_32x32x16_bf16 v[176:191], v[204:207], v[84:87], v[176:191]
  ds_read_b64_tr_b16 v[204:205], v17 offset:26624
  ds_read_b64_tr_b16 v[206:207], v17 offset:27136
  ds_read_b128 v[92:95], v11 offset:0
  s_waitcnt vmcnt(4) lgkmcnt(5)
  s_barrier
  v_mfma_f32_32x32x16_bf16 v[160:175], v[192:195], v[88:91], v[160:175]
  ds_read_b64_tr_b16 v[192:193], v16 offset:49152
  ds_read_b64_tr_b16 v[194:195], v16 offset:49664
  s_cmp_eq_u32 s54, 0
  s_cbranch_scc0 L_sig_8
  v_mov_b32 v25, 1
  s_mov_b64 exec, 1
  buffer_atomic_add v25, v2, s[48:51], s91 offen
  buffer_atomic_add v25, v2, s[48:51], s92 offen
  s_mov_b64 exec, -1
L_sig_8:
  v_mfma_f32_32x32x16_bf16 v[176:191], v[196:199], v[88:91], v[176:191]
  ds_read_b64_tr_b16 v[196:197], v16 offset:57344
  ds_read_b64_tr_b16 v[198:199], v16 offset:57856
  s_bfe_u32 s88, s63, 262172
  s_lshl_b32 s88, s88, 7
  s_add_u32 s88, s88, s66
  s_add_u32 m0, s78, 131072
  s_nop 0
  buffer_load_dwordx4 v3, s[32:35], s88 offen lds
  ds_read_b128 v[96:99], v8 offset:32768
  s_waitcnt lgkmcnt(5)
  v_mfma_f32_32x32x16_bf16 v[160:175], v[200:203], v[92:95], v[160:175]
  ds_read_b64_tr_b16 v[200:201], v16 offset:51200
  ds_read_b64_tr_b16 v[202:203], v16 offset:51712
  s_add_u32 m0, s78, 139264
  s_nop 0
  buffer_load_dwordx4 v4, s[32:35], s88 offen lds
  v_mfma_f32_32x32x16_bf16 v[176:191], v[204:207], v[92:95], v[176:191]
  ds_read_b64_tr_b16 v[204:205], v16 offset:59392
  ds_read_b64_tr_b16 v[206:207], v16 offset:59904
  ds_read_b128 v[100:103], v9 offset:32768
  s_waitcnt lgkmcnt(5)
  v_mfma_f32_32x32x16_bf16 v[160:175], v[192:195], v[96:99], v[160:175]
  ds_read_b64_tr_b16 v[192:193], v17 offset:49152
  ds_read_b64_tr_b16 v[194:195], v17 offset:49664
  s_bfe_u32 s89, s63, 262172
  s_mul_i32 s89, s89, 196608
  s_add_u32 s89, s89, s96
  s_add_u32 m0, s78, 147456
  s_nop 0
  buffer_load_dwordx4 v5, s[36:39], s89 offen lds
  v_mfma_f32_32x32x16_bf16 v[176:191], v[196:199], v[96:99], v[176:191]
  ds_read_b64_tr_b16 v[196:197], v17 offset:57344
  ds_read_b64_tr_b16 v[198:199], v17 offset:57856
  ds_read_b128 v[104:107], v10 offset:32768
  s_waitcnt lgkmcnt(5)
  v_mfma_f32_32x32x16_bf16 v[160:175], v[200:203], v[100:103], v[160:175]
  ds_read_b64_tr_b16 v[200:201], v17 offset:51200
  ds_read_b64_tr_b16 v[202:203], v17 offset:51712
  s_add_u32 m0, s78, 155648
  s_nop 0
  buffer_load_dwordx4 v6, s[36:39], s89 offen lds
  v_mfma_f32_32x32x16_bf16 v[176:191], v[204:207], v[100:103], v[176:191]
  ds_read_b64_tr_b16 v[204:205], v17 offset:59392
  ds_read_b64_tr_b16 v[206:207], v17 offset:59904
  ds_read_b128 v[108:111], v11 offset:32768
  s_waitcnt vmcnt(8) lgkmcnt(5)
  s_barrier
  v_mfma_f32_32x32x16_bf16 v[160:175], v[192:195], v[104:107], v[160:175]
  ds_read_b64_tr_b16 v[192:193], v221 offset:16384
  ds_read_b64_tr_b16 v[194:195], v221 offset:16896
  s_bfe_u32 s90, s63, 262144
  s_mul_i32 s90, s90, 196608
  s_add_u32 s90, s90, s96
  s_add_u32 m0, s78, 0
  s_nop 0
  buffer_load_dwordx4 v7, s[36:39], s90 offen lds
  v_mfma_f32_32x32x16_bf16 v[176:191], v[196:199], v[104:107], v[176:191]
  ds_read_b64_tr_b16 v[196:197], v221 offset:24576
  ds_read_b64_tr_b16 v[198:199], v221 offset:25088
  v_add_u32 v21, 65536, v8
  ds_read_b128 v[112:115], v21 offset:0
  s_waitcnt lgkmcnt(5)
  v_mfma_f32_32x32x16_bf16 v[160:175], v[200:203], v[108:111], v[160:175]
  ds_read_b64_tr_b16 v[200:201], v221 offset:18432
  ds_read_b64_tr_b16 v[202:203], v221 offset:18944
  buffer_load_dword v25, v2, s[48:51], s91 offen sc1
  buffer_load_dword v20, v2, s[48:51], s92 offen sc1
  v_mfma_f32_32x32x16_bf16 v[176:191], v[204:207], v[108:111], v[176:191]
  ds_read_b64_tr_b16 v[204:205], v221 offset:26624
  ds_read_b64_tr_b16 v[206:207], v221 offset:27136
  s_bfe_u32 s90, s63, 262148
  s_mul_i32 s90, s90, 196608
  s_add_u32 s90, s90, s96
  s_add_u32 m0, s78, 8192
  s_nop 0
  buffer_load_dwordx4 v7, s[36:39], s90 offen lds
  v_add_u32 v22, 65536, v9
  ds_read_b128 v[116:119], v22 offset:0
  s_waitcnt lgkmcnt(5)
  v_mfma_f32_32x32x16_bf16 v[160:175], v[192:195], v[112:115], v[160:175]
  ds_read_b64_tr_b16 v[192:193], v223 offset:16384
  ds_read_b64_tr_b16 v[194:195], v223 offset:16896
  s_bfe_u32 s90, s63, 262152
  s_mul_i32 s90, s90, 196608
  s_add_u32 s90, s90, s96
  s_add_u32 m0, s78, 16384
  s_nop 0
  buffer_load_dwordx4 v7, s[36:39], s90 offen lds
  v_mfma_f32_32x32x16_bf16 v[176:191], v[196:199], v[112:115], v[176:191]
  ds_read_b64_tr_b16 v[196:197], v223 offset:24576
  ds_read_b64_tr_b16 v[198:199], v223 offset:25088
  v_add_u32 v21, 65536, v10
  ds_read_b128 v[120:123], v21 offset:0
  s_waitcnt lgkmcnt(5)
  v_mfma_f32_32x32x16_bf16 v[160:175], v[200:203], v[116:119], v[160:175]
  ds_read_b64_tr_b16 v[200:201], v223 offset:18432
  ds_read_b64_tr_b16 v[202:203], v223 offset:18944
  s_bfe_u32 s90, s63, 262156
  s_mul_i32 s90, s90, 196608
  s_add_u32 s90, s90, s96
  s_add_u32 m0, s78, 24576
  s_nop 0
  buffer_load_dwordx4 v7, s[36:39], s90 offen lds
  v_mfma_f32_32x32x16_bf16 v[176:191], v[204:207], v[116:119], v[176:191]
  ds_read_b64_tr_b16 v[204:205], v223 offset:26624
  ds_read_b64_tr_b16 v[206:207], v223 offset:27136
  v_add_u32 v22, 65536, v11
  ds_read_b128 v[124:127], v22 offset:0
  s_waitcnt vmcnt(10) lgkmcnt(5)
  s_barrier
  v_mfma_f32_32x32x16_bf16 v[160:175], v[192:195], v[120:123], v[160:175]
  ds_read_b64_tr_b16 v[192:193], v221 offset:49152
  ds_read_b64_tr_b16 v[194:195], v221 offset:49664
  s_bfe_u32 s90, s63, 262160
  s_mul_i32 s90, s90, 196608
  s_add_u32 s90, s90, s96
  s_add_u32 m0, s78, 32768
  s_nop 0
  buffer_load_dwordx4 v7, s[36:39], s90 offen lds
  v_mfma_f32_32x32x16_bf16 v[176:191], v[196:199], v[120:123], v[176:191]
  ds_read_b64_tr_b16 v[196:197], v221 offset:57344
  ds_read_b64_tr_b16 v[198:199], v221 offset:57856
  v_add_u32 v21, 65536, v8
  ds_read_b128 v[128:131], v21 offset:32768
  s_waitcnt lgkmcnt(5)
  v_mfma_f32_32x32x16_bf16 v[160:175], v[200:203], v[124:127], v[160:175]
  ds_read_b64_tr_b16 v[200:201], v221 offset:51200
  ds_read_b64_tr_b16 v[202:203], v221 offset:51712
  s_bfe_u32 s90, s63, 262164
  s_mul_i32 s90, s90, 196608
  s_add_u32 s90, s90, s96
  s_add_u32 m0, s78, 40960
  s_nop 0
  buffer_load_dwordx4 v7, s[36:39], s90 offen lds
  v_mfma_f32_32x32x16_bf16 v[176:191], v[204:207], v[124:127], v[176:191]
  ds_read_b64_tr_b16 v[204:205], v221 offset:59392
  ds_read_b64_tr_b16 v[206:207], v221 offset:59904
  v_add_u32 v22, 65536, v9
  ds_read_b128 v[132:135], v22 offset:32768
  s_waitcnt lgkmcnt(5)
  v_mfma_f32_32x32x16_bf16 v[160:175], v[192:195], v[128:131], v[160:175]
  ds_read_b64_tr_b16 v[192:193], v223 offset:49152
  ds_read_b64_tr_b16 v[194:195], v223 offset:49664
  s_bfe_u32 s90, s63, 262168
  s_mul_i32 s90, s90, 196608
  s_add_u32 s90, s90, s96
  s_add_u32 m0, s78, 49152
  s_nop 0
  buffer_load_dwordx4 v7, s[36:39], s90 offen lds
  v_mfma_f32_32x32x16_bf16 v[176:191], v[196:199], v[128:131], v[176:191]
  ds_read_b64_tr_b16 v[196:197], v223 offset:57344
  ds_read_b64_tr_b16 v[198:199], v223 offset:57856
  v_add_u32 v21, 65536, v10
  ds_read_b128 v[136:139], v21 offset:32768
  s_waitcnt lgkmcnt(5)
  v_mfma_f32_32x32x16_bf16 v[160:175], v[200:203], v[132:135], v[160:175]
  ds_read_b64_tr_b16 v[200:201], v223 offset:51200
  ds_read_b64_tr_b16 v[202:203], v223 offset:51712
  s_waitcnt vmcnt(6)
  v_readfirstlane_b32 s69, v25
  s_nop 1
  s_cmp_lt_u32 s69, 16
  s_cbranch_scc1 L_slow_cs_a
L_back_cs_a:
  v_readfirstlane_b32 s69, v20
  s_nop 1
  s_cmp_lt_u32 s69, 8
  s_cbranch_scc1 L_slow_st_a
L_back_st_a:
  v_and_b32 v23, 31, v1
  v_lshlrev_b32 v23, 2, v23
  buffer_load_dword v248, v23, s[48:51], s67 offen offset:0 sc1
  buffer_load_dword v249, v23, s[48:51], s67 offen offset:128 sc1
  buffer_load_dword v250, v23, s[48:51], s67 offen offset:256 sc1
  buffer_load_dword v251, v23, s[48:51], s62 offen sc1
  s_add_u32 s70, s62, 8192
  buffer_load_dword v252, v23, s[48:51], s70 offen sc1
  v_mfma_f32_32x32x16_bf16 v[176:191], v[204:207], v[132:135], v[176:191]
  ds_read_b64_tr_b16 v[204:205], v223 offset:59392
  ds_read_b64_tr_b16 v[206:207], v223 offset:59904
  s_bfe_u32 s90, s63, 262172
  s_mul_i32 s90, s90, 196608
  s_add_u32 s90, s90, s96
  s_add_u32 m0, s78, 57344
  s_nop 0
  buffer_load_dwordx4 v7, s[36:39], s90 offen lds
  v_add_u32 v22, 65536, v11
  ds_read_b128 v[140:143], v22 offset:32768
  s_waitcnt vmcnt(15) lgkmcnt(5)
  s_barrier
  v_mfma_f32_32x32x16_bf16 v[160:175], v[192:195], v[136:139], v[160:175]
  ds_read_b64_tr_b16 v[192:193], v222 offset:16384
  ds_read_b64_tr_b16 v[194:195], v222 offset:16896
  v_mfma_f32_32x32x16_bf16 v[176:191], v[196:199], v[136:139], v[176:191]
  ds_read_b64_tr_b16 v[196:197], v222 offset:24576
  ds_read_b64_tr_b16 v[198:199], v222 offset:25088
  v_add_u32 v21, 131072, v8
  ds_read_b128 v[144:147], v21 offset:0
  s_waitcnt lgkmcnt(5)
  v_mfma_f32_32x32x16_bf16 v[160:175], v[200:203], v[140:143], v[160:175]
  ds_read_b64_tr_b16 v[200:201], v222 offset:18432
  ds_read_b64_tr_b16 v[202:203], v222 offset:18944
  v_mfma_f32_32x32x16_bf16 v[176:191], v[204:207], v[140:143], v[176:191]
  ds_read_b64_tr_b16 v[204:205], v222 offset:26624
  ds_read_b64_tr_b16 v[206:207], v222 offset:27136
  v_add_u32 v22, 131072, v9
  ds_read_b128 v[148:151], v22 offset:0
  s_waitcnt lgkmcnt(5)
  v_mfma_f32_32x32x16_bf16 v[160:175], v[192:195], v[144:147], v[160:175]
  ds_read_b64_tr_b16 v[192:193], v28 offset:16384
  ds_read_b64_tr_b16 v[194:195], v28 offset:16896
  s_lshr_b32 s69, s2, 3
  s_lshl_b32 s69, s69, 3
  s_add_u32 s69, s69, s54
  s_mul_i32 s70, s69, 11008
  v_lshlrev_b32 v30, 7, v1
  v_add_u32 v31, s70, v30
  global_load_dword v253, v31, s[22:23]
  v_mfma_f32_32x32x16_bf16 v[176:191], v[196:199], v[144:147], v[176:191]
  ds_read_b64_tr_b16 v[196:197], v28 offset:24576
  ds_read_b64_tr_b16 v[198:199], v28 offset:25088
  v_add_u32 v31, 8192, v31
  s_mov_b32 exec_lo, 0x3fffff
  s_mov_b32 exec_hi, 0
  global_load_dword v253, v31, s[22:23]
  s_lshl_b32 s70, s69, 12
  s_mov_b32 exec_lo, -1
  v_add_u32 v31, s70, v30
  global_load_dword v253, v31, s[14:15]
  s_mov_b32 exec_hi, -1
  v_add_u32 v21, 131072, v10
  ds_read_b128 v[152:155], v21 offset:0
  s_waitcnt lgkmcnt(5)
  v_mfma_f32_32x32x16_bf16 v[160:175], v[200:203], v[148:151], v[160:175]
  ds_read_b64_tr_b16 v[200:201], v28 offset:18432
  ds_read_b64_tr_b16 v[202:203], v28 offset:18944
  v_mfma_f32_32x32x16_bf16 v[176:191], v[204:207], v[148:151], v[176:191]
  ds_read_b64_tr_b16 v[204:205], v28 offset:26624
  ds_read_b64_tr_b16 v[206:207], v28 offset:27136
  v_add_u32 v22, 131072, v11
  ds_read_b128 v[156:159], v22 offset:0
  s_waitcnt lgkmcnt(5)
  s_barrier
  v_mfma_f32_32x32x16_bf16 v[160:175], v[192:195], v[152:155], v[160:175]
  v_mfma_f32_32x32x16_bf16 v[176:191], v[196:199], v[152:155], v[176:191]
  s_waitcnt lgkmcnt(0)
  v_mfma_f32_32x32x16_bf16 v[160:175], v[200:203], v[156:159], v[160:175]
  v_mfma_f32_32x32x16_bf16 v[176:191], v[204:207], v[156:159], v[176:191]
  s_waitcnt vmcnt(3) lgkmcnt(0)
  s_barrier
  s_mov_b32 s32, s22
  s_and_b32 s33, s23, 0xffff
  s_mov_b32 s34, 1409024
  s_mov_b32 s35, 0x20000
  s_lshl_b32 s98, s55, 11
  s_lshl_b32 s69, s56, 10
  s_add_u32 s98, s98, s69
  s_lshl_b32 s88, s87, 14
  s_cmp_eq_u32 s54, 1
  s_cbranch_scc0 L_ones_9
  v_mov_b32 v21, 0x3f803f80
  v_lshlrev_b32 v22, 2, v1
  v_and_b32 v22, 127, v22
  v_add_u32 v22, 108544, v22
  ds_write_b32 v22, v21
L_ones_9:
  v_cmp_gt_u32 vcc, 32, v1
  s_nop 1
  v_cndmask_b32 v24, 0, -1, vcc
  v_mov_b32 v242, 0
  v_mov_b32 v243, 0
  v_mov_b32 v246, 0
  v_mov_b32 v247, 0
  s_waitcnt vmcnt(4)
  v_mul_f32 v28, 0x3b000000, v251
  v_mul_f32 v30, 0x3b000000, v252
  v_fma_f32 v30, -v28, v28, v30
  v_max_f32 v30, 0, v30
  v_add_f32 v30, 0x3727c5ac, v30
  v_rsq_f32 v26, v30
  v_sub_f32 v28, 0, v28
  v_cvt_pk_bf16_f32 v244, v28, v28
  v_and_b32 v29, 0xffff0000, v244
  v_sub_f32 v29, v28, v29
  v_cvt_pk_bf16_f32 v245, v29, v2
  v_cvt_pk_bf16_f32 v240, v248, v248
  v_lshlrev_b32 v241, 16, v240
  v_sub_f32 v241, v248, v241
  v_cvt_pk_bf16_f32 v240, v248, v241
  v_and_b32 v240, v24, v240
  v_and_b32 v241, 0xffff, v240
  s_nop 1
  v_mfma_f32_32x32x16_bf16 v[160:175], v[240:243], v[244:247], v[160:175]
  v_cvt_pk_bf16_f32 v240, v249, v249
  v_lshlrev_b32 v241, 16, v240
  v_sub_f32 v241, v249, v241
  v_cvt_pk_bf16_f32 v240, v249, v241
  v_and_b32 v240, v24, v240
  v_and_b32 v241, 0xffff, v240
  s_nop 1
  v_mfma_f32_32x32x16_bf16 v[176:191], v[240:243], v[244:247], v[176:191]
  v_mul_f32 v232, 0x3fb8aa3b, v26
  s_nop 1
  v_cvt_pk_bf16_f32 v240, v160, v161
  v_cvt_pk_bf16_f32 v241, v162, v163
  v_cvt_pk_bf16_f32 v242, v164, v165
  v_cvt_pk_bf16_f32 v243, v166, v167
  v_cvt_pk_bf16_f32 v208, v168, v169
  v_cvt_pk_bf16_f32 v209, v170, v171
  v_cvt_pk_bf16_f32 v210, v172, v173
  v_cvt_pk_bf16_f32 v211, v174, v175
  v_mfma_f32_32x32x16_bf16 v[192:207], v[224:227], v[240:243], 0
  s_nop 0
  v_mfma_f32_32x32x16_bf16 v[160:175], v[228:231], v[208:211], 0
  v_mov_b32 v28, v26
  v_pk_mul_f32 v[176:177], v[176:177], v[28:29] op_sel:[0,0] op_sel_hi:[1,0]
  v_pk_mul_f32 v[178:179], v[178:179], v[28:29] op_sel:[0,0] op_sel_hi:[1,0]
  v_pk_mul_f32 v[180:181], v[180:181], v[28:29] op_sel:[0,0] op_sel_hi:[1,0]
  v_pk_mul_f32 v[182:183], v[182:183], v[28:29] op_sel:[0,0] op_sel_hi:[1,0]
  v_pk_mul_f32 v[184:185], v[184:185], v[28:29] op_sel:[0,0] op_sel_hi:[1,0]
  v_pk_mul_f32 v[186:187], v[186:187], v[28:29] op_sel:[0,0] op_sel_hi:[1,0]
  v_pk_mul_f32 v[188:189], v[188:189], v[28:29] op_sel:[0,0] op_sel_hi:[1,0]
  v_pk_mul_f32 v[190:191], v[190:191], v[28:29] op_sel:[0,0] op_sel_hi:[1,0]
  v_cvt_pk_bf16_f32 v208, v176, v177
  v_cvt_pk_bf16_f32 v209, v178, v179
  v_cvt_pk_bf16_f32 v210, v180, v181
  v_cvt_pk_bf16_f32 v211, v182, v183
  v_cvt_pk_bf16_f32 v212, v184, v185
  v_cvt_pk_bf16_f32 v213, v186, v187
  v_cvt_pk_bf16_f32 v214, v188, v189
  v_cvt_pk_bf16_f32 v215, v190, v191
  ds_write_b64 v18, v[208:209] offset:0
  ds_write_b64 v19, v[210:211] offset:0
  ds_write_b64 v18, v[212:213] offset:4096
  ds_write_b64 v19, v[214:215] offset:4096
  v_max3_f32 v234, v192, v193, v194
  v_max3_f32 v234, v234, v195, v196
  v_max3_f32 v234, v234, v197, v198
  v_max_f32 v234, v234, v199
  v_max3_f32 v235, v200, v201, v202
  v_max3_f32 v208, v160, v161, v162
  v_max3_f32 v235, v235, v203, v204
  v_max3_f32 v208, v208, v163, v164
  v_max3_f32 v235, v235, v205, v206
  v_max3_f32 v208, v208, v165, v166
  v_max_f32 v235, v235, v207
  v_max_f32 v208, v208, v167
  s_nop 0
  v_permlane32_swap_b32 v234, v235
  v_max3_f32 v209, v168, v169, v170
  v_max_f32 v234, v234, v235
  v_max3_f32 v209, v209, v171, v172
  v_mul_f32 v234, v234, v232
  v_max3_f32 v209, v209, v173, v174
  v_mov_b32 v235, v234
  v_max_f32 v209, v209, v175
  s_nop 0
  v_permlane32_swap_b32 v234, v235
  v_permlane32_swap_b32 v208, v209
  v_pk_fma_f32 v[192:193], v[192:193], v[232:233], v[234:235] op_sel:[0,0,0] op_sel_hi:[1,0,0] neg_lo:[0,0,1] neg_hi:[0,0,1]
  v_max_f32 v208, v208, v209
  v_pk_fma_f32 v[194:195], v[194:195], v[232:233], v[234:235] op_sel:[0,0,0] op_sel_hi:[1,0,0] neg_lo:[0,0,1] neg_hi:[0,0,1]
  v_mul_f32 v208, v208, v232
  v_pk_fma_f32 v[196:197], v[196:197], v[232:233], v[234:235] op_sel:[0,0,0] op_sel_hi:[1,0,0] neg_lo:[0,0,1] neg_hi:[0,0,1]
  v_mov_b32 v209, v208
  v_pk_fma_f32 v[198:199], v[198:199], v[232:233], v[234:235] op_sel:[0,0,0] op_sel_hi:[1,0,0] neg_lo:[0,0,1] neg_hi:[0,0,1]
  s_nop 0
  v_permlane32_swap_b32 v208, v209
  v_pk_fma_f32 v[200:201], v[200:201], v[232:233], v[234:235] op_sel:[0,0,1] op_sel_hi:[1,0,1] neg_lo:[0,0,1] neg_hi:[0,0,1]
  v_pk_fma_f32 v[160:161], v[160:161], v[232:233], v[208:209] op_sel:[0,0,0] op_sel_hi:[1,0,0] neg_lo:[0,0,1] neg_hi:[0,0,1]
  v_pk_fma_f32 v[202:203], v[202:203], v[232:233], v[234:235] op_sel:[0,0,1] op_sel_hi:[1,0,1] neg_lo:[0,0,1] neg_hi:[0,0,1]
  v_pk_fma_f32 v[162:163], v[162:163], v[232:233], v[208:209] op_sel:[0,0,0] op_sel_hi:[1,0,0] neg_lo:[0,0,1] neg_hi:[0,0,1]
  v_pk_fma_f32 v[204:205], v[204:205], v[232:233], v[234:235] op_sel:[0,0,1] op_sel_hi:[1,0,1] neg_lo:[0,0,1] neg_hi:[0,0,1]
  v_pk_fma_f32 v[164:165], v[164:165], v[232:233], v[208:209] op_sel:[0,0,0] op_sel_hi:[1,0,0] neg_lo:[0,0,1] neg_hi:[0,0,1]
  v_pk_fma_f32 v[206:207], v[206:207], v[232:233], v[234:235] op_sel:[0,0,1] op_sel_hi:[1,0,1] neg_lo:[0,0,1] neg_hi:[0,0,1]
  v_pk_fma_f32 v[166:167], v[166:167], v[232:233], v[208:209] op_sel:[0,0,0] op_sel_hi:[1,0,0] neg_lo:[0,0,1] neg_hi:[0,0,1]
  v_exp_f32 v192, v192
  v_pk_fma_f32 v[168:169], v[168:169], v[232:233], v[208:209] op_sel:[0,0,1] op_sel_hi:[1,0,1] neg_lo:[0,0,1] neg_hi:[0,0,1]
  v_exp_f32 v193, v193
  v_pk_fma_f32 v[170:171], v[170:171], v[232:233], v[208:209] op_sel:[0,0,1] op_sel_hi:[1,0,1] neg_lo:[0,0,1] neg_hi:[0,0,1]
  v_exp_f32 v194, v194
  v_pk_fma_f32 v[172:173], v[172:173], v[232:233], v[208:209] op_sel:[0,0,1] op_sel_hi:[1,0,1] neg_lo:[0,0,1] neg_hi:[0,0,1]
  v_exp_f32 v195, v195
  v_pk_fma_f32 v[174:175], v[174:175], v[232:233], v[208:209] op_sel:[0,0,1] op_sel_hi:[1,0,1] neg_lo:[0,0,1] neg_hi:[0,0,1]
  v_exp_f32 v196, v196
  v_exp_f32 v160, v160
  v_exp_f32 v197, v197
  v_exp_f32 v161, v161
  v_exp_f32 v198, v198
  v_exp_f32 v162, v162
  v_exp_f32 v199, v199
  v_exp_f32 v163, v163
  v_exp_f32 v200, v200
  v_exp_f32 v164, v164
  v_exp_f32 v201, v201
  v_exp_f32 v165, v165
  v_exp_f32 v202, v202
  v_exp_f32 v166, v166
  v_exp_f32 v203, v203
  v_exp_f32 v167, v167
  v_exp_f32 v204, v204
  v_exp_f32 v168, v168
  v_exp_f32 v205, v205
  v_exp_f32 v169, v169
  v_exp_f32 v206, v206
  v_exp_f32 v170, v170
  v_exp_f32 v207, v207
  v_exp_f32 v171, v171
  v_pk_add_f32 v[236:237], v[192:193], v[194:195]
  v_exp_f32 v172, v172
  v_pk_add_f32 v[236:237], v[236:237], v[196:197]
  v_exp_f32 v173, v173
  v_pk_add_f32 v[236:237], v[236:237], v[198:199]
  v_exp_f32 v174, v174
  v_pk_add_f32 v[238:239], v[200:201], v[202:203]
  v_exp_f32 v175, v175
  v_pk_add_f32 v[238:239], v[238:239], v[204:205]
  v_pk_add_f32 v[210:211], v[160:161], v[162:163]
  v_pk_add_f32 v[238:239], v[238:239], v[206:207]
  v_pk_add_f32 v[210:211], v[210:211], v[164:165]
  v_add_f32 v234, v236, v237
  v_pk_add_f32 v[210:211], v[210:211], v[166:167]
  v_add_f32 v235, v238, v239
  v_pk_add_f32 v[212:213], v[168:169], v[170:171]
  s_nop 0
  v_permlane32_swap_b32 v234, v235
  v_pk_add_f32 v[212:213], v[212:213], v[172:173]
  v_add_f32 v234, v234, v235
  v_pk_add_f32 v[212:213], v[212:213], v[174:175]
  v_rcp_f32 v234, v234
  v_add_f32 v208, v210, v211
  v_mov_b32 v235, v234
  v_add_f32 v209, v212, v213
  s_nop 0
  v_permlane32_swap_b32 v234, v235
  v_permlane32_swap_b32 v208, v209
  v_pk_mul_f32 v[192:193], v[192:193], v[234:235] op_sel:[0,0] op_sel_hi:[1,0]
  v_add_f32 v208, v208, v209
  v_pk_mul_f32 v[194:195], v[194:195], v[234:235] op_sel:[0,0] op_sel_hi:[1,0]
  v_rcp_f32 v208, v208
  v_pk_mul_f32 v[196:197], v[196:197], v[234:235] op_sel:[0,0] op_sel_hi:[1,0]
  v_mov_b32 v209, v208
  v_pk_mul_f32 v[198:199], v[198:199], v[234:235] op_sel:[0,0] op_sel_hi:[1,0]
  s_nop 0
  v_permlane32_swap_b32 v208, v209
  v_pk_mul_f32 v[200:201], v[200:201], v[234:235] op_sel:[0,1] op_sel_hi:[1,1]
  v_pk_mul_f32 v[160:161], v[160:161], v[208:209] op_sel:[0,0] op_sel_hi:[1,0]
  v_pk_mul_f32 v[202:203], v[202:203], v[234:235] op_sel:[0,1] op_sel_hi:[1,1]
  v_pk_mul_f32 v[162:163], v[162:163], v[208:209] op_sel:[0,0] op_sel_hi:[1,0]
  v_pk_mul_f32 v[204:205], v[204:205], v[234:235] op_sel:[0,1] op_sel_hi:[1,1]
  v_pk_mul_f32 v[164:165], v[164:165], v[208:209] op_sel:[0,0] op_sel_hi:[1,0]
  v_pk_mul_f32 v[206:207], v[206:207], v[234:235] op_sel:[0,1] op_sel_hi:[1,1]
  v_pk_mul_f32 v[166:167], v[166:167], v[208:209] op_sel:[0,0] op_sel_hi:[1,0]
  v_cvt_pk_bf16_f32 v176, v192, v193
  v_pk_mul_f32 v[168:169], v[168:169], v[208:209] op_sel:[0,1] op_sel_hi:[1,1]
  v_cvt_pk_bf16_f32 v177, v194, v195
  v_pk_mul_f32 v[170:171], v[170:171], v[208:209] op_sel:[0,1] op_sel_hi:[1,1]
  v_cvt_pk_bf16_f32 v178, v196, v197
  v_pk_mul_f32 v[172:173], v[172:173], v[208:209] op_sel:[0,1] op_sel_hi:[1,1]
  v_cvt_pk_bf16_f32 v179, v198, v199
  v_pk_mul_f32 v[174:175], v[174:175], v[208:209] op_sel:[0,1] op_sel_hi:[1,1]
  v_cvt_pk_bf16_f32 v180, v200, v201
  v_cvt_pk_bf16_f32 v184, v160, v161
  v_cvt_pk_bf16_f32 v181, v202, v203
  v_cvt_pk_bf16_f32 v185, v162, v163
  v_cvt_pk_bf16_f32 v182, v204, v205
  v_cvt_pk_bf16_f32 v186, v164, v165
  v_cvt_pk_bf16_f32 v183, v206, v207
  v_cvt_pk_bf16_f32 v187, v166, v167
  ds_write_b64 v12, v[176:177] offset:0
  v_cvt_pk_bf16_f32 v188, v168, v169
  ds_write_b64 v13, v[178:179] offset:0
  v_cvt_pk_bf16_f32 v189, v170, v171
  ds_write_b64 v14, v[180:181] offset:0
  v_cvt_pk_bf16_f32 v190, v172, v173
  ds_write_b64 v15, v[182:183] offset:0
  v_cvt_pk_bf16_f32 v191, v174, v175
  ds_write_b64 v12, v[184:185] offset:8192
  ds_write_b64 v13, v[186:187] offset:8192
  ds_write_b64 v14, v[188:189] offset:8192
  ds_write_b64 v15, v[190:191] offset:8192
  s_waitcnt lgkmcnt(0)
  s_barrier
  s_cmp_eq_u32 s56, 0
  s_cbranch_scc0 L_nokv_10
  ds_read_b64_tr_b16 v[176:177], v218
  ds_read_b64_tr_b16 v[178:179], v219
  ds_read_b64_tr_b16 v[180:181], v216 offset:0
  ds_read_b64_tr_b16 v[182:183], v217 offset:0
  v_add_u32 v218, v218, v220
  v_add_u32 v219, v219, v220
  ds_read_b64_tr_b16 v[184:185], v218
  ds_read_b64_tr_b16 v[186:187], v219
  ds_read_b64_tr_b16 v[188:189], v216 offset:1024
  ds_read_b64_tr_b16 v[190:191], v217 offset:1024
  v_add_u32 v218, v218, v220
  v_add_u32 v219, v219, v220
  ds_read_b64_tr_b16 v[192:193], v218
  ds_read_b64_tr_b16 v[194:195], v219
  ds_read_b64_tr_b16 v[196:197], v216 offset:2048
  ds_read_b64_tr_b16 v[198:199], v217 offset:2048
  v_add_u32 v218, v218, v220
  v_add_u32 v219, v219, v220
  ds_read_b64_tr_b16 v[200:201], v218
  ds_read_b64_tr_b16 v[202:203], v219
  ds_read_b64_tr_b16 v[204:205], v216 offset:3072
  ds_read_b64_tr_b16 v[206:207], v217 offset:3072
  v_add_u32 v218, v218, v220
  v_add_u32 v219, v219, v220
  s_waitcnt lgkmcnt(12)
  v_mfma_f32_32x32x16_bf16 v[160:175], v[176:179], v[180:183], 0
  s_waitcnt lgkmcnt(8)
  v_mfma_f32_32x32x16_bf16 v[160:175], v[184:187], v[188:191], v[160:175]
  s_waitcnt lgkmcnt(4)
  v_mfma_f32_32x32x16_bf16 v[160:175], v[192:195], v[196:199], v[160:175]
  s_waitcnt lgkmcnt(0)
  v_mfma_f32_32x32x16_bf16 v[160:175], v[200:203], v[204:207], v[160:175]
  ds_read_b64_tr_b16 v[176:177], v218
  ds_read_b64_tr_b16 v[178:179], v219
  ds_read_b64_tr_b16 v[180:181], v216 offset:4096
  ds_read_b64_tr_b16 v[182:183], v217 offset:4096
  v_add_u32 v218, v218, v220
  v_add_u32 v219, v219, v220
  ds_read_b64_tr_b16 v[184:185], v218
  ds_read_b64_tr_b16 v[186:187], v219
  ds_read_b64_tr_b16 v[188:189], v216 offset:5120
  ds_read_b64_tr_b16 v[190:191], v217 offset:5120
  v_add_u32 v218, v218, v220
  v_add_u32 v219, v219, v220
  ds_read_b64_tr_b16 v[192:193], v218
  ds_read_b64_tr_b16 v[194:195], v219
  ds_read_b64_tr_b16 v[196:197], v216 offset:6144
  ds_read_b64_tr_b16 v[198:199], v217 offset:6144
  v_add_u32 v218, v218, v220
  v_add_u32 v219, v219, v220
  ds_read_b64_tr_b16 v[200:201], v218
  ds_read_b64_tr_b16 v[202:203], v219
  ds_read_b64_tr_b16 v[204:205], v216 offset:7168
  ds_read_b64_tr_b16 v[206:207], v217 offset:7168
  s_waitcnt lgkmcnt(12)
  v_mfma_f32_32x32x16_bf16 v[160:175], v[176:179], v[180:183], v[160:175]
  s_waitcnt lgkmcnt(8)
  v_mfma_f32_32x32x16_bf16 v[160:175], v[184:187], v[188:191], v[160:175]
  s_waitcnt lgkmcnt(4)
  v_mfma_f32_32x32x16_bf16 v[160:175], v[192:195], v[196:199], v[160:175]
  s_waitcnt lgkmcnt(0)
  v_mfma_f32_32x32x16_bf16 v[160:175], v[200:203], v[204:207], v[160:175]
  v_and_b32 v22, 31, v1
  v_lshlrev_b32 v22, 2, v22
  v_lshrrev_b32 v23, 5, v1
  v_lshlrev_b32 v23, 9, v23
  v_add_u32 v23, v23, v22
  s_nop 6
  buffer_atomic_add_f32 v160, v23, s[48:51], s93 offen offset:0
  buffer_atomic_add_f32 v161, v23, s[48:51], s93 offen offset:128
  buffer_atomic_add_f32 v162, v23, s[48:51], s93 offen offset:256
  buffer_atomic_add_f32 v163, v23, s[48:51], s93 offen offset:384
  buffer_atomic_add_f32 v164, v23, s[48:51], s93 offen offset:1024
  buffer_atomic_add_f32 v165, v23, s[48:51], s93 offen offset:1152
  buffer_atomic_add_f32 v166, v23, s[48:51], s93 offen offset:1280
  buffer_atomic_add_f32 v167, v23, s[48:51], s93 offen offset:1408
  s_mov_b32 exec_hi, 0
  buffer_atomic_add_f32 v168, v22, s[48:51], s93 offen offset:2048
  s_mov_b32 exec_hi, -1
L_nokv_10:
  ds_read_b64_tr_b16 v[192:193], v16 offset:0
  ds_read_b64_tr_b16 v[194:195], v16 offset:512
  ds_read_b64_tr_b16 v[196:197], v16 offset:2048
  ds_read_b64_tr_b16 v[198:199], v16 offset:2560
  ds_read_b64_tr_b16 v[200:201], v17 offset:0
  ds_read_b64_tr_b16 v[202:203], v17 offset:512
  ds_read_b64_tr_b16 v[204:205], v17 offset:2048
  ds_read_b64_tr_b16 v[206:207], v17 offset:2560
  s_waitcnt lgkmcnt(6)
  v_mfma_f32_32x32x16_bf16 v[176:191], v[192:195], v[32:35], 0
  ds_read_b64_tr_b16 v[192:193], v16 offset:8192
  ds_read_b64_tr_b16 v[194:195], v16 offset:8704
  s_waitcnt lgkmcnt(6)
  v_mfma_f32_32x32x16_bf16 v[176:191], v[196:199], v[36:39], v[176:191]
  s_add_u32 s73, s3, 0
  s_cmp_ge_u32 s73, s4
  s_cselect_b32 s71, s4, 0
  s_sub_u32 s73, s73, s71
  s_lshl_b32 s73, s73, 14
  s_add_u32 s73, s73, s88
  s_add_u32 m0, s98, 65536
  s_nop 0
  buffer_load_dwordx4 v27, s[32:35], s73 offen lds
  ds_read_b64_tr_b16 v[196:197], v16 offset:10240
  ds_read_b64_tr_b16 v[198:199], v16 offset:10752
  s_waitcnt lgkmcnt(6)
  v_mfma_f32_32x32x16_bf16 v[176:191], v[200:203], v[40:43], v[176:191]
  ds_read_b64_tr_b16 v[200:201], v17 offset:8192
  ds_read_b64_tr_b16 v[202:203], v17 offset:8704
  s_waitcnt lgkmcnt(6)
  v_mfma_f32_32x32x16_bf16 v[176:191], v[204:207], v[44:47], v[176:191]
  ds_read_b64_tr_b16 v[204:205], v17 offset:10240
  ds_read_b64_tr_b16 v[206:207], v17 offset:10752
  s_waitcnt lgkmcnt(6)
  v_mfma_f32_32x32x16_bf16 v[176:191], v[192:195], v[48:51], v[176:191]
  ds_read_b64_tr_b16 v[192:193], v16 offset:16384
  ds_read_b64_tr_b16 v[194:195], v16 offset:16896
  s_waitcnt lgkmcnt(6)
  v_mfma_f32_32x32x16_bf16 v[176:191], v[196:199], v[52:55], v[176:191]
  s_add_u32 s73, s3, 1
  s_cmp_ge_u32 s73, s4
  s_cselect_b32 s71, s4, 0
  s_sub_u32 s73, s73, s71
  s_lshl_b32 s73, s73, 14
  s_add_u32 s73, s73, s88
  s_add_u32 m0, s98, 73728
  s_nop 0
  buffer_load_dwordx4 v27, s[32:35], s73 offen lds
  ds_read_b64_tr_b16 v[196:197], v16 offset:18432
  ds_read_b64_tr_b16 v[198:199], v16 offset:18944
  s_waitcnt lgkmcnt(6)
  v_mfma_f32_32x32x16_bf16 v[176:191], v[200:203], v[56:59], v[176:191]
  ds_read_b64_tr_b16 v[200:201], v17 offset:16384
  ds_read_b64_tr_b16 v[202:203], v17 offset:16896
  s_waitcnt lgkmcnt(6)
  v_mfma_f32_32x32x16_bf16 v[176:191], v[204:207], v[60:63], v[176:191]
  ds_read_b64_tr_b16 v[204:205], v17 offset:18432
  ds_read_b64_tr_b16 v[206:207], v17 offset:18944
  s_waitcnt lgkmcnt(6)
  v_mfma_f32_32x32x16_bf16 v[176:191], v[192:195], v[64:67], v[176:191]
  ds_read_b64_tr_b16 v[192:193], v16 offset:24576
  ds_read_b64_tr_b16 v[194:195], v16 offset:25088
  s_waitcnt lgkmcnt(6)
  v_mfma_f32_32x32x16_bf16 v[176:191], v[196:199], v[68:71], v[176:191]
  s_add_u32 s73, s3, 2
  s_cmp_ge_u32 s73, s4
  s_cselect_b32 s71, s4, 0
  s_sub_u32 s73, s73, s71
  s_lshl_b32 s73, s73, 14
  s_add_u32 s73, s73, s88
  s_add_u32 m0, s98, 81920
  s_nop 0
  buffer_load_dwordx4 v27, s[32:35], s73 offen lds
  ds_read_b64_tr_b16 v[196:197], v16 offset:26624
  ds_read_b64_tr_b16 v[198:199], v16 offset:27136
  s_waitcnt lgkmcnt(6)
  v_mfma_f32_32x32x16_bf16 v[176:191], v[200:203], v[72:75], v[176:191]
  ds_read_b64_tr_b16 v[200:201], v17 offset:24576
  ds_read_b64_tr_b16 v[202:203], v17 offset:25088
  s_waitcnt lgkmcnt(6)
  v_mfma_f32_32x32x16_bf16 v[176:191], v[204:207], v[76:79], v[176:191]
  ds_read_b64_tr_b16 v[204:205], v17 offset:26624
  ds_read_b64_tr_b16 v[206:207], v17 offset:27136
  s_waitcnt lgkmcnt(6)
  v_mfma_f32_32x32x16_bf16 v[176:191], v[192:195], v[80:83], v[176:191]
  ds_read_b64_tr_b16 v[192:193], v16 offset:32768
  ds_read_b64_tr_b16 v[194:195], v16 offset:33280
  s_waitcnt lgkmcnt(6)
  v_mfma_f32_32x32x16_bf16 v[176:191], v[196:199], v[84:87], v[176:191]
  s_add_u32 s73, s3, 3
  s_cmp_ge_u32 s73, s4
  s_cselect_b32 s71, s4, 0
  s_sub_u32 s73, s73, s71
  s_lshl_b32 s73, s73, 14
  s_add_u32 s73, s73, s88
  s_add_u32 m0, s98, 90112
  s_nop 0
  buffer_load_dwordx4 v27, s[32:35], s73 offen lds
  ds_read_b64_tr_b16 v[196:197], v16 offset:34816
  ds_read_b64_tr_b16 v[198:199], v16 offset:35328
  s_waitcnt lgkmcnt(6)
  v_mfma_f32_32x32x16_bf16 v[176:191], v[200:203], v[88:91], v[176:191]
  ds_read_b64_tr_b16 v[200:201], v17 offset:32768
  ds_read_b64_tr_b16 v[202:203], v17 offset:33280
  s_waitcnt lgkmcnt(6)
  v_mfma_f32_32x32x16_bf16 v[176:191], v[204:207], v[92:95], v[176:191]
  ds_read_b64_tr_b16 v[204:205], v17 offset:34816
  ds_read_b64_tr_b16 v[206:207], v17 offset:35328
  s_waitcnt lgkmcnt(6)
  v_mfma_f32_32x32x16_bf16 v[176:191], v[192:195], v[96:99], v[176:191]
  ds_read_b64_tr_b16 v[192:193], v16 offset:40960
  ds_read_b64_tr_b16 v[194:195], v16 offset:41472
  s_waitcnt lgkmcnt(6)
  v_mfma_f32_32x32x16_bf16 v[176:191], v[196:199], v[100:103], v[176:191]
  ds_read_b64_tr_b16 v[196:197], v16 offset:43008
  ds_read_b64_tr_b16 v[198:199], v16 offset:43520
  s_waitcnt lgkmcnt(6)
  v_mfma_f32_32x32x16_bf16 v[176:191], v[200:203], v[104:107], v[176:191]
  ds_read_b64_tr_b16 v[200:201], v17 offset:40960
  ds_read_b64_tr_b16 v[202:203], v17 offset:41472
  s_waitcnt lgkmcnt(6)
  v_mfma_f32_32x32x16_bf16 v[176:191], v[204:207], v[108:111], v[176:191]
  ds_read_b64_tr_b16 v[204:205], v17 offset:43008
  ds_read_b64_tr_b16 v[206:207], v17 offset:43520
  s_waitcnt lgkmcnt(6)
  v_mfma_f32_32x32x16_bf16 v[176:191], v[192:195], v[112:115], v[176:191]
  ds_read_b64_tr_b16 v[192:193], v16 offset:49152
  ds_read_b64_tr_b16 v[194:195], v16 offset:49664
  s_waitcnt lgkmcnt(6)
  v_mfma_f32_32x32x16_bf16 v[176:191], v[196:199], v[116:119], v[176:191]
  ds_read_b64_tr_b16 v[196:197], v16 offset:51200
  ds_read_b64_tr_b16 v[198:199], v16 offset:51712
  s_waitcnt lgkmcnt(6)
  v_mfma_f32_32x32x16_bf16 v[176:191], v[200:203], v[120:123], v[176:191]
  ds_read_b64_tr_b16 v[200:201], v17 offset:49152
  ds_read_b64_tr_b16 v[202:203], v17 offset:49664
  s_waitcnt lgkmcnt(6)
  v_mfma_f32_32x32x16_bf16 v[176:191], v[204:207], v[124:127], v[176:191]
  ds_read_b64_tr_b16 v[204:205], v17 offset:51200
  ds_read_b64_tr_b16 v[206:207], v17 offset:51712
  s_waitcnt lgkmcnt(6)
  v_mfma_f32_32x32x16_bf16 v[176:191], v[192:195], v[128:131], v[176:191]
  ds_read_b64_tr_b16 v[192:193], v16 offset:57344
  ds_read_b64_tr_b16 v[194:195], v16 offset:57856
  s_waitcnt lgkmcnt(6)
  v_mfma_f32_32x32x16_bf16 v[176:191], v[196:199], v[132:135], v[176:191]
  ds_read_b64_tr_b16 v[196:197], v16 offset:59392
  ds_read_b64_tr_b16 v[198:199], v16 offset:59904
  s_waitcnt lgkmcnt(6)
  v_mfma_f32_32x32x16_bf16 v[176:191], v[200:203], v[136:139], v[176:191]
  ds_read_b64_tr_b16 v[200:201], v17 offset:57344
  ds_read_b64_tr_b16 v[202:203], v17 offset:57856
  s_waitcnt lgkmcnt(6)
  v_mfma_f32_32x32x16_bf16 v[176:191], v[204:207], v[140:143], v[176:191]
  ds_read_b64_tr_b16 v[204:205], v17 offset:59392
  ds_read_b64_tr_b16 v[206:207], v17 offset:59904
  s_waitcnt lgkmcnt(6)
  v_mfma_f32_32x32x16_bf16 v[176:191], v[192:195], v[144:147], v[176:191]
  s_waitcnt lgkmcnt(4)
  v_mfma_f32_32x32x16_bf16 v[176:191], v[196:199], v[148:151], v[176:191]
  s_waitcnt lgkmcnt(2)
  v_mfma_f32_32x32x16_bf16 v[176:191], v[200:203], v[152:155], v[176:191]
  s_waitcnt lgkmcnt(0)
  v_mfma_f32_32x32x16_bf16 v[176:191], v[204:207], v[156:159], v[176:191]
  v_mov_b32 v242, 0
  v_mov_b32 v243, 0
  v_cvt_pk_bf16_f32 v240, v250, v250
  v_lshlrev_b32 v241, 16, v240
  v_sub_f32 v241, v250, v241
  v_cvt_pk_bf16_f32 v240, v250, v241
  v_and_b32 v240, v24, v240
  v_and_b32 v241, 0xffff, v240
  s_nop 1
  v_mfma_f32_32x32x16_bf16 v[176:191], v[240:243], v[244:247], v[176:191]
  s_waitcnt vmcnt(0)
  s_barrier
  s_cmp_eq_u32 s54, 0
  s_cbranch_scc0 L_sig_11
  s_add_u32 s70, s82, 16
  s_lshl_b32 s70, s70, 7
  s_add_u32 s70, s70, 8497152
  v_mov_b32 v31, s70
  v_mov_b32 v30, 1
  s_mov_b64 s[30:31], exec
  s_mov_b64 exec, 1
  buffer_atomic_add v30, v31, s[48:51], 0 offen
  s_mov_b64 exec, s[30:31]
L_sig_11:
  s_mov_b32 s32, s22
  s_and_b32 s33, s23, 0xffff
  s_mov_b32 s34, 1409024
  s_mov_b32 s35, 0x20000
  s_mov_b32 s36, s14
  s_and_b32 s37, s15, 0xffff
  s_mov_b32 s38, 524288
  s_mov_b32 s39, 0x20000
  s_lshl_b32 s89, s87, 14
  s_lshl_b32 s90, s55, 17
  s_lshl_b32 s78, s55, 11
  s_lshl_b32 s69, s56, 10
  s_add_u32 s78, s78, s69
  v_cvt_pk_bf16_f32 v240, v176, v177
  v_cvt_pk_bf16_f32 v241, v178, v179
  v_cvt_pk_bf16_f32 v242, v180, v181
  v_cvt_pk_bf16_f32 v243, v182, v183
  v_cvt_pk_bf16_f32 v208, v184, v185
  v_cvt_pk_bf16_f32 v209, v186, v187
  v_cvt_pk_bf16_f32 v210, v188, v189
  v_cvt_pk_bf16_f32 v211, v190, v191
  s_add_u32 s73, s3, 4
  s_cmp_ge_u32 s73, s4
  s_cselect_b32 s71, s4, 0
  s_sub_u32 s73, s73, s71
  s_lshl_b32 s73, s73, 14
  s_add_u32 s73, s73, s88
  s_add_u32 m0, s98, 0
  s_nop 0
  buffer_load_dwordx4 v27, s[32:35], s73 offen lds
  v_mfma_f32_32x32x16_bf16 v[192:207], v[224:227], v[240:243], 0
  v_mfma_f32_32x32x16_bf16 v[160:175], v[228:231], v[208:211], 0
  s_nop 10
  v_max3_f32 v234, v192, v193, v194
  v_max3_f32 v234, v234, v195, v196
  v_max3_f32 v234, v234, v197, v198
  v_max_f32 v234, v234, v199
  v_max3_f32 v235, v200, v201, v202
  v_max3_f32 v208, v160, v161, v162
  s_add_u32 s73, s3, 5
  s_cmp_ge_u32 s73, s4
  s_cselect_b32 s71, s4, 0
  s_sub_u32 s73, s73, s71
  s_lshl_b32 s73, s73, 14
  s_add_u32 s73, s73, s88
  s_add_u32 m0, s98, 8192
  s_nop 0
  buffer_load_dwordx4 v27, s[32:35], s73 offen lds
  v_max3_f32 v235, v235, v203, v204
  v_max3_f32 v208, v208, v163, v164
  v_max3_f32 v235, v235, v205, v206
  v_max3_f32 v208, v208, v165, v166
  v_max_f32 v235, v235, v207
  v_max_f32 v208, v208, v167
  s_nop 0
  v_permlane32_swap_b32 v234, v235
  v_max3_f32 v209, v168, v169, v170
  s_add_u32 s73, s3, 6
  s_cmp_ge_u32 s73, s4
  s_cselect_b32 s71, s4, 0
  s_sub_u32 s73, s73, s71
  s_lshl_b32 s73, s73, 14
  s_add_u32 s73, s73, s88
  s_add_u32 m0, s98, 16384
  s_nop 0
  buffer_load_dwordx4 v27, s[32:35], s73 offen lds
  v_max_f32 v234, v234, v235
  v_max3_f32 v209, v209, v171, v172
  v_mul_f32 v234, v234, v232
  v_max3_f32 v209, v209, v173, v174
  v_mov_b32 v235, v234
  v_max_f32 v209, v209, v175
  s_nop 0
  v_permlane32_swap_b32 v234, v235
  v_permlane32_swap_b32 v208, v209
  s_add_u32 s73, s3, 7
  s_cmp_ge_u32 s73, s4
  s_cselect_b32 s71, s4, 0
  s_sub_u32 s73, s73, s71
  s_lshl_b32 s73, s73, 14
  s_add_u32 s73, s73, s88
  s_add_u32 m0, s98, 24576
  s_nop 0
  buffer_load_dwordx4 v27, s[32:35], s73 offen lds
  v_pk_fma_f32 v[192:193], v[192:193], v[232:233], v[234:235] op_sel:[0,0,0] op_sel_hi:[1,0,0] neg_lo:[0,0,1] neg_hi:[0,0,1]
  v_max_f32 v208, v208, v209
  v_pk_fma_f32 v[194:195], v[194:195], v[232:233], v[234:235] op_sel:[0,0,0] op_sel_hi:[1,0,0] neg_lo:[0,0,1] neg_hi:[0,0,1]
  v_mul_f32 v208, v208, v232
  v_pk_fma_f32 v[196:197], v[196:197], v[232:233], v[234:235] op_sel:[0,0,0] op_sel_hi:[1,0,0] neg_lo:[0,0,1] neg_hi:[0,0,1]
  v_mov_b32 v209, v208
  v_pk_fma_f32 v[198:199], v[198:199], v[232:233], v[234:235] op_sel:[0,0,0] op_sel_hi:[1,0,0] neg_lo:[0,0,1] neg_hi:[0,0,1]
  s_nop 0
  v_permlane32_swap_b32 v208, v209
  s_add_u32 s73, s3, 8
  s_cmp_ge_u32 s73, s4
  s_cselect_b32 s71, s4, 0
  s_sub_u32 s73, s73, s71
  s_lshl_b32 s73, s73, 14
  s_add_u32 s73, s73, s88
  s_add_u32 m0, s98, 32768
  s_nop 0
  buffer_load_dwordx4 v27, s[32:35], s73 offen lds
  v_pk_fma_f32 v[200:201], v[200:201], v[232:233], v[234:235] op_sel:[0,0,1] op_sel_hi:[1,0,1] neg_lo:[0,0,1] neg_hi:[0,0,1]
  v_pk_fma_f32 v[160:161], v[160:161], v[232:233], v[208:209] op_sel:[0,0,0] op_sel_hi:[1,0,0] neg_lo:[0,0,1] neg_hi:[0,0,1]
  v_pk_fma_f32 v[202:203], v[202:203], v[232:233], v[234:235] op_sel:[0,0,1] op_sel_hi:[1,0,1] neg_lo:[0,0,1] neg_hi:[0,0,1]
  v_pk_fma_f32 v[162:163], v[162:163], v[232:233], v[208:209] op_sel:[0,0,0] op_sel_hi:[1,0,0] neg_lo:[0,0,1] neg_hi:[0,0,1]
  v_pk_fma_f32 v[204:205], v[204:205], v[232:233], v[234:235] op_sel:[0,0,1] op_sel_hi:[1,0,1] neg_lo:[0,0,1] neg_hi:[0,0,1]
  v_pk_fma_f32 v[164:165], v[164:165], v[232:233], v[208:209] op_sel:[0,0,0] op_sel_hi:[1,0,0] neg_lo:[0,0,1] neg_hi:[0,0,1]
  v_pk_fma_f32 v[206:207], v[206:207], v[232:233], v[234:235] op_sel:[0,0,1] op_sel_hi:[1,0,1] neg_lo:[0,0,1] neg_hi:[0,0,1]
  v_pk_fma_f32 v[166:167], v[166:167], v[232:233], v[208:209] op_sel:[0,0,0] op_sel_hi:[1,0,0] neg_lo:[0,0,1] neg_hi:[0,0,1]
  s_add_u32 s73, s3, 9
  s_cmp_ge_u32 s73, s4
  s_cselect_b32 s71, s4, 0
  s_sub_u32 s73, s73, s71
  s_lshl_b32 s73, s73, 14
  s_add_u32 s73, s73, s88
  s_add_u32 m0, s98, 40960
  s_nop 0
  buffer_load_dwordx4 v27, s[32:35], s73 offen lds
  v_exp_f32 v192, v192
  v_pk_fma_f32 v[168:169], v[168:169], v[232:233], v[208:209] op_sel:[0,0,1] op_sel_hi:[1,0,1] neg_lo:[0,0,1] neg_hi:[0,0,1]
  v_exp_f32 v193, v193
  v_pk_fma_f32 v[170:171], v[170:171], v[232:233], v[208:209] op_sel:[0,0,1] op_sel_hi:[1,0,1] neg_lo:[0,0,1] neg_hi:[0,0,1]
  v_exp_f32 v194, v194
  v_pk_fma_f32 v[172:173], v[172:173], v[232:233], v[208:209] op_sel:[0,0,1] op_sel_hi:[1,0,1] neg_lo:[0,0,1] neg_hi:[0,0,1]
  v_exp_f32 v195, v195
  v_pk_fma_f32 v[174:175], v[174:175], v[232:233], v[208:209] op_sel:[0,0,1] op_sel_hi:[1,0,1] neg_lo:[0,0,1] neg_hi:[0,0,1]
  s_add_u32 s74, s3, 20
  s_cmp_ge_u32 s74, s4
  s_cselect_b32 s71, s4, 0
  s_sub_u32 s74, s74, s71
  s_lshl_b32 s74, s74, 14
  s_add_u32 s74, s74, s89
  s_add_u32 m0, s78, 49152
  s_nop 0
  buffer_load_dwordx4 v27, s[32:35], s74 offen lds
  v_exp_f32 v196, v196
  v_exp_f32 v160, v160
  v_exp_f32 v197, v197
  v_exp_f32 v161, v161
  v_exp_f32 v198, v198
  v_exp_f32 v162, v162
  v_exp_f32 v199, v199
  v_exp_f32 v163, v163
  s_add_u32 s74, s3, 21
  s_cmp_ge_u32 s74, s4
  s_cselect_b32 s71, s4, 0
  s_sub_u32 s74, s74, s71
  s_lshl_b32 s74, s74, 14
  s_add_u32 s74, s74, s89
  s_add_u32 m0, s78, 57344
  s_nop 0
  buffer_load_dwordx4 v27, s[32:35], s74 offen lds
  v_exp_f32 v200, v200
  v_exp_f32 v164, v164
  v_exp_f32 v201, v201
  v_exp_f32 v165, v165
  v_exp_f32 v202, v202
  v_exp_f32 v166, v166
  v_exp_f32 v203, v203
  s_lshl_b32 s70, s82, 7
  s_add_u32 s70, s70, 8499200
  buffer_load_dword v25, v2, s[48:51], s70 offen sc1
  v_exp_f32 v167, v167
  v_exp_f32 v204, v204
  v_exp_f32 v168, v168
  v_exp_f32 v205, v205
  v_exp_f32 v169, v169
  v_exp_f32 v206, v206
  v_exp_f32 v170, v170
  v_exp_f32 v207, v207
  s_add_u32 s74, s5, 0
  s_and_b32 s74, s74, 7
  s_lshl_b32 s74, s74, 14
  s_add_u32 s74, s74, s90
  s_add_u32 m0, s78, 98304
  s_nop 0
  buffer_load_dwordx4 v27, s[36:39], s74 offen lds
  v_exp_f32 v171, v171
  v_pk_add_f32 v[236:237], v[192:193], v[194:195]
  v_exp_f32 v172, v172
  v_pk_add_f32 v[236:237], v[236:237], v[196:197]
  v_exp_f32 v173, v173
  v_pk_add_f32 v[236:237], v[236:237], v[198:199]
  v_exp_f32 v174, v174
  v_pk_add_f32 v[238:239], v[200:201], v[202:203]
  s_add_u32 s74, s5, 1
  s_and_b32 s74, s74, 7
  s_lshl_b32 s74, s74, 14
  s_add_u32 s74, s74, s90
  s_add_u32 m0, s78, 106496
  s_nop 0
  buffer_load_dwordx4 v27, s[36:39], s74 offen lds
  v_exp_f32 v175, v175
  v_pk_add_f32 v[238:239], v[238:239], v[204:205]
  v_pk_add_f32 v[210:211], v[160:161], v[162:163]
  v_pk_add_f32 v[238:239], v[238:239], v[206:207]
  v_pk_add_f32 v[210:211], v[210:211], v[164:165]
  v_add_f32 v234, v236, v237
  v_pk_add_f32 v[210:211], v[210:211], v[166:167]
  v_add_f32 v235, v238, v239
  s_add_u32 s74, s5, 2
  s_and_b32 s74, s74, 7
  s_lshl_b32 s74, s74, 14
  s_add_u32 s74, s74, s90
  s_add_u32 m0, s78, 114688
  s_nop 0
  buffer_load_dwordx4 v27, s[36:39], s74 offen lds
  v_pk_add_f32 v[212:213], v[168:169], v[170:171]
  v_permlane32_swap_b32 v234, v235
  v_pk_add_f32 v[212:213], v[212:213], v[172:173]
  v_add_f32 v234, v234, v235
  v_pk_add_f32 v[212:213], v[212:213], v[174:175]
  v_rcp_f32 v234, v234
  v_add_f32 v208, v210, v211
  v_mov_b32 v235, v234
  s_add_u32 s74, s5, 3
  s_and_b32 s74, s74, 7
  s_lshl_b32 s74, s74, 14
  s_add_u32 s74, s74, s90
  s_add_u32 m0, s78, 122880
  s_nop 0
  buffer_load_dwordx4 v27, s[36:39], s74 offen lds
  v_add_f32 v209, v212, v213
  v_permlane32_swap_b32 v234, v235
  s_nop 0
  v_permlane32_swap_b32 v208, v209
  v_pk_mul_f32 v[192:193], v[192:193], v[234:235] op_sel:[0,0] op_sel_hi:[1,0]
  v_add_f32 v208, v208, v209
  v_pk_mul_f32 v[194:195], v[194:195], v[234:235] op_sel:[0,0] op_sel_hi:[1,0]
  v_rcp_f32 v208, v208
  v_pk_mul_f32 v[196:197], v[196:197], v[234:235] op_sel:[0,0] op_sel_hi:[1,0]
  s_add_u32 s74, s5, 4
  s_and_b32 s74, s74, 7
  s_lshl_b32 s74, s74, 14
  s_add_u32 s74, s74, s90
  s_add_u32 m0, s78, 131072
  s_nop 0
  buffer_load_dwordx4 v27, s[36:39], s74 offen lds
  v_mov_b32 v209, v208
  v_pk_mul_f32 v[198:199], v[198:199], v[234:235] op_sel:[0,0] op_sel_hi:[1,0]
  s_nop 0
  v_permlane32_swap_b32 v208, v209
  v_pk_mul_f32 v[200:201], v[200:201], v[234:235] op_sel:[0,1] op_sel_hi:[1,1]
  v_pk_mul_f32 v[160:161], v[160:161], v[208:209] op_sel:[0,0] op_sel_hi:[1,0]
  v_pk_mul_f32 v[202:203], v[202:203], v[234:235] op_sel:[0,1] op_sel_hi:[1,1]
  v_pk_mul_f32 v[162:163], v[162:163], v[208:209] op_sel:[0,0] op_sel_hi:[1,0]
  v_pk_mul_f32 v[204:205], v[204:205], v[234:235] op_sel:[0,1] op_sel_hi:[1,1]
  s_add_u32 s74, s5, 5
  s_and_b32 s74, s74, 7
  s_lshl_b32 s74, s74, 14
  s_add_u32 s74, s74, s90
  s_add_u32 m0, s78, 139264
  s_nop 0
  buffer_load_dwordx4 v27, s[36:39], s74 offen lds
  v_pk_mul_f32 v[164:165], v[164:165], v[208:209] op_sel:[0,0] op_sel_hi:[1,0]
  v_pk_mul_f32 v[206:207], v[206:207], v[234:235] op_sel:[0,1] op_sel_hi:[1,1]
  v_pk_mul_f32 v[166:167], v[166:167], v[208:209] op_sel:[0,0] op_sel_hi:[1,0]
  v_cvt_pk_bf16_f32 v96, v192, v193
  v_pk_mul_f32 v[168:169], v[168:169], v[208:209] op_sel:[0,1] op_sel_hi:[1,1]
  v_cvt_pk_bf16_f32 v97, v194, v195
  v_pk_mul_f32 v[170:171], v[170:171], v[208:209] op_sel:[0,1] op_sel_hi:[1,1]
  v_cvt_pk_bf16_f32 v98, v196, v197
  s_add_u32 s74, s5, 6
  s_and_b32 s74, s74, 7
  s_lshl_b32 s74, s74, 14
  s_add_u32 s74, s74, s90
  s_add_u32 m0, s78, 147456
  s_nop 0
  buffer_load_dwordx4 v27, s[36:39], s74 offen lds
  v_pk_mul_f32 v[172:173], v[172:173], v[208:209] op_sel:[0,1] op_sel_hi:[1,1]
  v_cvt_pk_bf16_f32 v99, v198, v199
  v_pk_mul_f32 v[174:175], v[174:175], v[208:209] op_sel:[0,1] op_sel_hi:[1,1]
  v_cvt_pk_bf16_f32 v100, v200, v201
  v_cvt_pk_bf16_f32 v104, v160, v161
  v_cvt_pk_bf16_f32 v101, v202, v203
  v_cvt_pk_bf16_f32 v105, v162, v163
  v_cvt_pk_bf16_f32 v102, v204, v205
  s_add_u32 s74, s5, 7
  s_and_b32 s74, s74, 7
  s_lshl_b32 s74, s74, 14
  s_add_u32 s74, s74, s90
  s_add_u32 m0, s78, 155648
  s_nop 0
  buffer_load_dwordx4 v27, s[36:39], s74 offen lds
  v_cvt_pk_bf16_f32 v106, v164, v165
  v_cvt_pk_bf16_f32 v103, v206, v207
  v_cvt_pk_bf16_f32 v107, v166, v167
  v_cvt_pk_bf16_f32 v108, v168, v169
  v_cvt_pk_bf16_f32 v109, v170, v171
  v_cvt_pk_bf16_f32 v110, v172, v173
  v_cvt_pk_bf16_f32 v111, v174, v175
  v_lshrrev_b32 v21, 5, v1
  v_lshlrev_b32 v21, 2, v21
  v_bfe_u32 v23, v1, 2, 2
  v_add_u32 v21, v21, v23
  v_lshlrev_b32 v21, 7, v21
  v_lshrrev_b32 v23, 1, v23
  v_lshlrev_b32 v23, 6, v23
  v_add_u32 v21, v21, v23
  v_bfe_u32 v23, v1, 4, 1
  v_lshlrev_b32 v23, 5, v23
  v_add_u32 v21, v21, v23
  v_and_b32 v23, 3, v1
  v_lshlrev_b32 v23, 3, v23
  v_add_u32 v21, v21, v23
  s_lshl_b32 s69, s55, 11
  v_add_u32 v12, s69, v21
  v_xor_b32 v13, 64, v12
  v_add_u32 v14, 65536, v12
  v_add_u32 v15, 65536, v13
  v_add_u32 v18, 131072, v12
  v_add_u32 v19, 131072, v13
  s_waitcnt vmcnt(8)
  s_cmp_eq_u32 s54, 0
  s_cbranch_scc0 L_kvw_12
  v_readfirstlane_b32 s69, v25
  s_nop 1
  s_cmp_ge_u32 s69, 16
  s_cbranch_scc1 L_kvw_12
  s_add_u32 s70, s82, 16
  s_lshl_b32 s70, s70, 7
  s_add_u32 s70, s70, 8497152
  v_mov_b32 v31, s70
  s_mov_b32 s83, 0
  buffer_load_dword v28, v31, s[48:51], 0 offen sc1
  s_sleep 1
  buffer_load_dword v29, v31, s[48:51], 0 offen sc1
  s_sleep 1
  buffer_load_dword v30, v31, s[48:51], 0 offen sc1
L_plkv_13:
  s_waitcnt vmcnt(2)
  v_readfirstlane_b32 s69, v28
  s_nop 1
  s_cmp_ge_u32 s69, 16
  s_cbranch_scc1 L_pdkv_14
  buffer_load_dword v28, v31, s[48:51], 0 offen sc1
  s_waitcnt vmcnt(2)
  v_readfirstlane_b32 s69, v29
  s_nop 1
  s_cmp_ge_u32 s69, 16
  s_cbranch_scc1 L_pdkv_14
  buffer_load_dword v29, v31, s[48:51], 0 offen sc1
  s_waitcnt vmcnt(2)
  v_readfirstlane_b32 s69, v30
  s_nop 1
  s_cmp_ge_u32 s69, 16
  s_cbranch_scc1 L_pdkv_14
  buffer_load_dword v30, v31, s[48:51], 0 offen sc1
  s_add_u32 s83, s83, 1
  s_cmp_lt_u32 s83, 32768
  s_cbranch_scc1 L_plkv_13
L_pdkv_14:
  s_waitcnt vmcnt(0)
L_kvw_12:
  s_barrier
  v_and_b32 v21, 31, v1
  v_min_u32 v21, 16, v21
  v_lshlrev_b32 v21, 7, v21
  v_lshrrev_b32 v22, 5, v1
  v_lshlrev_b32 v22, 4, v22
  v_add_u32 v28, v21, v22
  v_lshlrev_b32 v29, 4, v1
  buffer_load_dwordx4 v[128:131], v28, s[48:51], s94 offen offset:0 sc1
  buffer_load_dwordx4 v[132:135], v28, s[48:51], s94 offen offset:32 sc1
  buffer_load_dwordx4 v[136:139], v28, s[48:51], s94 offen offset:64 sc1
  buffer_load_dwordx4 v[140:143], v28, s[48:51], s94 offen offset:96 sc1
  buffer_load_dwordx4 v[144:147], v28, s[48:51], s94 offen offset:2176 sc1
  buffer_load_dwordx4 v[148:151], v28, s[48:51], s94 offen offset:2208 sc1
  buffer_load_dwordx4 v[152:155], v28, s[48:51], s94 offen offset:2240 sc1
  buffer_load_dwordx4 v[156:159], v28, s[48:51], s94 offen offset:2272 sc1
  s_lshl_b32 s72, s84, 2
  s_add_u32 s72, s72, s55
  s_add_u32 s70, s72, 40
  s_lshl_b32 s70, s70, 7
  s_add_u32 s70, s70, 8497152
  v_mov_b32 v31, s70
  buffer_load_dword v25, v31, s[48:51], 0 offen sc1
  ds_read_b64_tr_b16 v[40:41], v14 offset:0
  ds_read_b64_tr_b16 v[42:43], v14 offset:1024
  ds_read_b64_tr_b16 v[44:45], v15 offset:0
  ds_read_b64_tr_b16 v[46:47], v15 offset:1024
  ds_read_b64_tr_b16 v[48:49], v14 offset:8192
  ds_read_b64_tr_b16 v[50:51], v14 offset:9216
  ds_read_b64_tr_b16 v[52:53], v15 offset:8192
  ds_read_b64_tr_b16 v[54:55], v15 offset:9216
  ds_read_b64_tr_b16 v[56:57], v14 offset:16384
  ds_read_b64_tr_b16 v[58:59], v14 offset:17408
  ds_read_b64_tr_b16 v[60:61], v15 offset:16384
  ds_read_b64_tr_b16 v[62:63], v15 offset:17408
  ds_read_b64_tr_b16 v[64:65], v14 offset:24576
  ds_read_b64_tr_b16 v[66:67], v14 offset:25600
  ds_read_b64_tr_b16 v[68:69], v15 offset:24576
  ds_read_b64_tr_b16 v[70:71], v15 offset:25600
  ds_read_b64_tr_b16 v[72:73], v12 offset:0
  ds_read_b64_tr_b16 v[74:75], v12 offset:1024
  ds_read_b64_tr_b16 v[76:77], v13 offset:0
  ds_read_b64_tr_b16 v[78:79], v13 offset:1024
  ds_read_b64_tr_b16 v[80:81], v12 offset:8192
  ds_read_b64_tr_b16 v[82:83], v12 offset:9216
  ds_read_b64_tr_b16 v[84:85], v13 offset:8192
  ds_read_b64_tr_b16 v[86:87], v13 offset:9216
  ds_read_b64_tr_b16 v[192:193], v12 offset:16384
  ds_read_b64_tr_b16 v[194:195], v12 offset:17408
  ds_read_b64_tr_b16 v[196:197], v13 offset:16384
  ds_read_b64_tr_b16 v[198:199], v13 offset:17408
  ds_read_b64_tr_b16 v[200:201], v12 offset:24576
  ds_read_b64_tr_b16 v[202:203], v12 offset:25600
  ds_read_b64_tr_b16 v[204:205], v13 offset:24576
  ds_read_b64_tr_b16 v[206:207], v13 offset:25600
  ds_read_b64_tr_b16 v[208:209], v12 offset:32768
  ds_read_b64_tr_b16 v[210:211], v12 offset:33792
  ds_read_b64_tr_b16 v[212:213], v13 offset:32768
  ds_read_b64_tr_b16 v[214:215], v13 offset:33792
  ds_read_b64_tr_b16 v[216:217], v12 offset:40960
  ds_read_b64_tr_b16 v[218:219], v12 offset:41984
  ds_read_b64_tr_b16 v[220:221], v13 offset:40960
  ds_read_b64_tr_b16 v[222:223], v13 offset:41984
  s_mov_b32 s40, s8
  s_and_b32 s41, s9, 0xffff
  s_mov_b32 s42, 2097152
  s_mov_b32 s43, 0x20000
  s_mov_b32 s44, s24
  s_and_b32 s45, s25, 0xffff
  s_mov_b32 s46, 2097152
  s_mov_b32 s47, 0x20000
  v_and_b32 v21, 31, v1
  s_lshl_b32 s69, s86, 5
  v_add_u32 v21, s69, v21
  v_lshlrev_b32 v21, 10, v21
  s_lshl_b32 s69, s85, 7
  s_lshl_b32 s70, s55, 5
  s_add_u32 s69, s69, s70
  v_add_u32 v21, s69, v21
  v_lshrrev_b32 v22, 5, v1
  v_lshlrev_b32 v23, 3, v22
  v_add_u32 v240, v21, v23
  v_lshlrev_b32 v23, 4, v22
  v_add_u32 v241, v21, v23
  buffer_load_dwordx2 v[32:33], v240, s[40:43], 0 offen
  buffer_load_dwordx2 v[34:35], v240, s[40:43], 0 offen offset:16
  v_lshlrev_b32 v242, 4, v1
  s_mul_i32 s69, s86, 86
  s_add_u32 s69, s69, s87
  s_lshl_b32 s98, s69, 10
  s_lshl_b32 s69, s86, 5
  s_lshl_b32 s70, s55, 3
  s_add_u32 s69, s69, s70
  s_lshl_b32 s69, s69, 10
  s_add_u32 s99, s69, 6291456
  s_waitcnt lgkmcnt(0)
  s_barrier
  s_add_u32 s74, s3, 10
  s_cmp_ge_u32 s74, s4
  s_cselect_b32 s71, s4, 0
  s_sub_u32 s74, s74, s71
  s_lshl_b32 s74, s74, 14
  s_add_u32 s74, s74, s89
  s_add_u32 m0, s78, 0
  s_nop 0
  buffer_load_dwordx4 v27, s[32:35], s74 offen lds
  s_add_u32 s74, s3, 11
  s_cmp_ge_u32 s74, s4
  s_cselect_b32 s71, s4, 0
  s_sub_u32 s74, s74, s71
  s_lshl_b32 s74, s74, 14
  s_add_u32 s74, s74, s89
  s_add_u32 m0, s78, 8192
  s_nop 0
  buffer_load_dwordx4 v27, s[32:35], s74 offen lds
  s_add_u32 s74, s3, 12
  s_cmp_ge_u32 s74, s4
  s_cselect_b32 s71, s4, 0
  s_sub_u32 s74, s74, s71
  s_lshl_b32 s74, s74, 14
  s_add_u32 s74, s74, s89
  s_add_u32 m0, s78, 16384
  s_nop 0
  buffer_load_dwordx4 v27, s[32:35], s74 offen lds
  s_waitcnt vmcnt(6)
  s_mov_b32 s76, 0
  v_cvt_pk_bf16_f32 v160, v128, v129
  v_cvt_pk_bf16_f32 v161, v130, v131
  v_cvt_pk_bf16_f32 v162, v132, v133
  v_cvt_pk_bf16_f32 v163, v134, v135
  v_cvt_pk_bf16_f32 v164, v136, v137
  v_cvt_pk_bf16_f32 v165, v138, v139
  v_cvt_pk_bf16_f32 v166, v140, v141
  v_cvt_pk_bf16_f32 v167, v142, v143
  v_cvt_pk_bf16_f32 v168, v144, v145
  v_cvt_pk_bf16_f32 v169, v146, v147
  v_cvt_pk_bf16_f32 v170, v148, v149
  v_cvt_pk_bf16_f32 v171, v150, v151
  v_cvt_pk_bf16_f32 v172, v152, v153
  v_cvt_pk_bf16_f32 v173, v154, v155
  v_cvt_pk_bf16_f32 v174, v156, v157
  v_cvt_pk_bf16_f32 v175, v158, v159
  v_mfma_f32_32x32x16_bf16 v[112:127], v[160:163], v[96:99], 0
  v_mfma_f32_32x32x16_bf16 v[112:127], v[164:167], v[100:103], v[112:127]
  v_mfma_f32_32x32x16_bf16 v[176:191], v[168:171], v[104:107], 0
  v_mfma_f32_32x32x16_bf16 v[176:191], v[172:175], v[108:111], v[176:191]
  s_nop 9
  v_add_f32 v120, 0x358637bd, v120
  v_rcp_f32 v120, v120
  s_nop 0
  v_pk_mul_f32 v[112:113], v[112:113], v[120:121] op_sel:[0,0] op_sel_hi:[1,0]
  v_pk_mul_f32 v[114:115], v[114:115], v[120:121] op_sel:[0,0] op_sel_hi:[1,0]
  v_pk_mul_f32 v[116:117], v[116:117], v[120:121] op_sel:[0,0] op_sel_hi:[1,0]
  v_pk_mul_f32 v[118:119], v[118:119], v[120:121] op_sel:[0,0] op_sel_hi:[1,0]
  v_cvt_pk_bf16_f32 v128, v112, v113
  v_cvt_pk_bf16_f32 v129, v114, v115
  v_cvt_pk_bf16_f32 v130, v116, v117
  v_cvt_pk_bf16_f32 v131, v118, v119
  buffer_store_dwordx4 v[128:131], v29, s[48:51], s95 offen offset:0 sc1
  v_add_f32 v184, 0x358637bd, v184
  v_rcp_f32 v184, v184
  s_nop 0
  v_pk_mul_f32 v[176:177], v[176:177], v[184:185] op_sel:[0,0] op_sel_hi:[1,0]
  v_pk_mul_f32 v[178:179], v[178:179], v[184:185] op_sel:[0,0] op_sel_hi:[1,0]
  v_pk_mul_f32 v[180:181], v[180:181], v[184:185] op_sel:[0,0] op_sel_hi:[1,0]
  v_pk_mul_f32 v[182:183], v[182:183], v[184:185] op_sel:[0,0] op_sel_hi:[1,0]
  v_cvt_pk_bf16_f32 v132, v176, v177
  v_cvt_pk_bf16_f32 v133, v178, v179
  v_cvt_pk_bf16_f32 v134, v180, v181
  v_cvt_pk_bf16_f32 v135, v182, v183
  buffer_store_dwordx4 v[132:135], v29, s[48:51], s95 offen offset:1024 sc1
  s_add_u32 s74, s3, 13
  s_cmp_ge_u32 s74, s4
  s_cselect_b32 s71, s4, 0
  s_sub_u32 s74, s74, s71
  s_lshl_b32 s74, s74, 14
  s_add_u32 s74, s74, s89
  s_add_u32 m0, s78, 24576
  s_nop 0
  buffer_load_dwordx4 v27, s[32:35], s74 offen lds
  s_add_u32 s74, s3, 14
  s_cmp_ge_u32 s74, s4
  s_cselect_b32 s71, s4, 0
  s_sub_u32 s74, s74, s71
  s_lshl_b32 s74, s74, 14
  s_add_u32 s74, s74, s89
  s_add_u32 m0, s78, 32768
  s_nop 0
  buffer_load_dwordx4 v27, s[32:35], s74 offen lds
  s_add_u32 s74, s3, 15
  s_cmp_ge_u32 s74, s4
  s_cselect_b32 s71, s4, 0
  s_sub_u32 s74, s74, s71
  s_lshl_b32 s74, s74, 14
  s_add_u32 s74, s74, s89
  s_add_u32 m0, s78, 40960
  s_nop 0
  buffer_load_dwordx4 v27, s[32:35], s74 offen lds
  s_add_u32 s74, s3, 16
  s_cmp_ge_u32 s74, s4
  s_cselect_b32 s71, s4, 0
  s_sub_u32 s74, s74, s71
  s_lshl_b32 s74, s74, 14
  s_add_u32 s74, s74, s89
  s_add_u32 m0, s78, 65536
  s_nop 0
  buffer_load_dwordx4 v27, s[32:35], s74 offen lds
  s_add_u32 s74, s3, 17
  s_cmp_ge_u32 s74, s4
  s_cselect_b32 s71, s4, 0
  s_sub_u32 s74, s74, s71
  s_lshl_b32 s74, s74, 14
  s_add_u32 s74, s74, s89
  s_add_u32 m0, s78, 73728
  s_nop 0
  buffer_load_dwordx4 v27, s[32:35], s74 offen lds
  s_add_u32 s74, s3, 18
  s_cmp_ge_u32 s74, s4
  s_cselect_b32 s71, s4, 0
  s_sub_u32 s74, s74, s71
  s_lshl_b32 s74, s74, 14
  s_add_u32 s74, s74, s89
  s_add_u32 m0, s78, 81920
  s_nop 0
  buffer_load_dwordx4 v27, s[32:35], s74 offen lds
  s_add_u32 s74, s3, 19
  s_cmp_ge_u32 s74, s4
  s_cselect_b32 s71, s4, 0
  s_sub_u32 s74, s74, s71
  s_lshl_b32 s74, s74, 14
  s_add_u32 s74, s74, s89
  s_add_u32 m0, s78, 90112
  s_nop 0
  buffer_load_dwordx4 v27, s[32:35], s74 offen lds
  s_mov_b32 s97, 1
  s_branch L_phase2
L_ffn:
  s_lshl_b32 s69, s61, 1
  s_add_u32 s69, s69, s60
  s_sub_u32 s69, s69, 2
  s_add_u32 s81, s69, 8
  s_mul_i32 s80, s69, 11
  s_sub_i32 s70, s69, 5
  s_max_i32 s70, s70, 0
  s_sub_u32 s80, s80, s70
  s_add_u32 s73, s54, 8
  s_sub_u32 s71, s54, 3
  s_cmp_le_u32 s54, 2
  s_cselect_b32 s73, s73, s71
  s_cselect_b32 s72, 0, 11392
  s_lshl_b32 s75, s54, 10
  s_lshl_b32 s76, s73, 10
  s_add_u32 s76, s76, s72
  s_add_u32 s74, s54, 5
  s_lshl_b32 s77, s74, 10
  s_add_u32 s77, s77, 11392
  s_mov_b32 s71, 2979
  s_mov_b32 s72, 2752
  s_lshl_b32 s69, s54, 6
  v_add_u32 v21, s69, v1
  v_mul_u32_u24 v22, s71, v21
  v_lshrrev_b32 v22, 16, v22
  v_mul_u32_u24 v23, 22, v22
  v_sub_u32 v23, v21, v23
  v_lshlrev_b32 v23, 4, v23
  v_mul_u32_u24 v22, s72, v22
  v_add_u32 v5, v22, v23
  s_lshl_b32 s69, s73, 6
  v_add_u32 v21, s69, v1
  v_mul_u32_u24 v22, s71, v21
  v_lshrrev_b32 v22, 16, v22
  v_mul_u32_u24 v23, 22, v22
  v_sub_u32 v23, v21, v23
  v_lshlrev_b32 v23, 4, v23
  v_mul_u32_u24 v22, s72, v22
  v_add_u32 v6, v22, v23
  s_lshl_b32 s69, s74, 6
  v_add_u32 v21, s69, v1
  v_mul_u32_u24 v22, s71, v21
  v_lshrrev_b32 v22, 16, v22
  v_mul_u32_u24 v23, 22, v22
  v_sub_u32 v23, v21, v23
  v_lshlrev_b32 v23, 4, v23
  v_mul_u32_u24 v22, s72, v22
  v_add_u32 v7, v22, v23
  s_cmp_ge_u32 s54, 6
  s_cselect_b32 s69, 2146435072, 0
  s_cselect_b32 s79, 0, -1
  s_cselect_b32 s77, 162432, s77
  v_or_b32 v7, s69, v7
  s_lshl_b32 s69, s80, 5
  s_mul_i32 s70, s101, 88064
  s_add_u32 s64, s69, s70
  s_add_u32 s65, s69, 88064
  s_sub_u32 s65, s65, s70
  s_waitcnt lgkmcnt(0)
  s_and_b32 s69, s2, 0x86
  s_cmp_eq_u32 s69, 0x80
  s_cbranch_scc0 L_zskip_15
  s_mov_b32 s48, s28
  s_and_b32 s49, s29, 0xffff
  s_mov_b32 s50, 9437184
  s_mov_b32 s51, 0x20000
  v_mov_b32 v192, 0
  v_mov_b32 v196, -1
  v_mov_b32 v193, 0
  v_mov_b32 v197, -1
  v_mov_b32 v194, 0
  v_mov_b32 v198, -1
  v_mov_b32 v195, 0
  v_mov_b32 v199, -1
  s_lshr_b32 s69, s2, 2
  s_and_b32 s69, s69, 30
  s_and_b32 s70, s2, 1
  s_or_b32 s71, s69, s70
  v_lshlrev_b32 v21, 4, v0
  s_mul_i32 s69, s71, 4064
  s_add_u32 s69, s69, 8388608
  v_cmp_gt_u32 vcc, 254, v0
  s_nop 1
  s_and_saveexec_b64 s[30:31], vcc
  s_cbranch_execz L_zs_16
  buffer_store_dwordx4 v[192:195], v21, s[48:51], s69 offen sc1
L_zs_16:
  s_mov_b64 exec, s[30:31]
  s_waitcnt vmcnt(0)
  s_barrier
  s_cmp_eq_u32 s54, 0
  s_cbranch_scc0 L_zskip_15
  v_mov_b32 v193, 1
  s_mov_b64 s[30:31], exec
  s_mov_b64 exec, 1
  global_atomic_add v192, v193, s[26:27]
  s_mov_b64 exec, s[30:31]
L_zskip_15:
  s_mov_b32 s32, s8
  s_and_b32 s33, s9, 0xffff
  s_mov_b32 s34, 2097152
  s_mov_b32 s35, 0x20000
  s_mov_b32 s36, s18
  s_and_b32 s37, s19, 0xffff
  s_mov_b32 s38, 1409024
  s_mov_b32 s39, 0x20000
  s_mov_b32 s44, s20
  s_and_b32 s45, s21, 0xffff
  s_mov_b32 s46, 1409024
  s_mov_b32 s47, 0x20000
  s_cmp_le_u32 s54, 2
  s_cselect_b32 s40, s18, s20
  s_cselect_b32 s41, s19, s21
  s_and_b32 s41, s41, 0xffff
  s_mov_b32 s42, 1409024
  s_mov_b32 s43, 0x20000
  s_bfe_u32 s88, s63, 262144
  s_lshl_b32 s88, s88, 7
  s_add_u32 s88, s88, s66
  s_add_u32 m0, s78, 113280
  s_nop 0
  buffer_load_dwordx4 v3, s[32:35], s88 offen lds
  s_add_u32 m0, s78, 121472
  s_nop 0
  buffer_load_dwordx4 v4, s[32:35], s88 offen lds
  s_bfe_u32 s89, s63, 262144
  s_mul_i32 s89, s89, 176128
  s_add_u32 s89, s89, s64
  s_add_u32 m0, s75, 0
  s_nop 0
  buffer_load_dwordx4 v5, s[36:39], s89 offen lds
  s_add_u32 m0, s76, 0
  s_nop 0
  buffer_load_dwordx4 v6, s[40:43], s89 offen lds
  s_and_b32 s74, s79, 0
  s_add_u32 m0, s74, s77
  s_nop 0
  buffer_load_dwordx4 v7, s[44:47], s89 offen lds
  s_bfe_u32 s90, s63, 262144
  s_mul_i32 s90, s90, 176128
  s_add_u32 s90, s90, s65
  s_add_u32 m0, s75, 22656
  s_nop 0
  buffer_load_dwordx4 v5, s[36:39], s90 offen lds
  s_add_u32 m0, s76, 22656
  s_nop 0
  buffer_load_dwordx4 v6, s[40:43], s90 offen lds
  s_and_b32 s74, s79, 22656
  s_add_u32 m0, s74, s77
  s_nop 0
  buffer_load_dwordx4 v7, s[44:47], s90 offen lds
  s_mov_b32 s48, s28
  s_and_b32 s49, s29, 0xffff
  s_mov_b32 s50, 9437184
  s_mov_b32 s51, 0x20000
  v_mov_b32 v2, 0
  s_and_b32 s55, s54, 3
  s_lshr_b32 s56, s54, 2
  s_and_b32 s69, s2, 7
  s_lshr_b32 s70, s2, 3
  s_and_b32 s85, s70, 7
  s_lshr_b32 s71, s70, 3
  s_lshl_b32 s86, s69, 3
  s_lshl_b32 s71, s71, 1
  s_add_u32 s86, s86, s71
  s_lshr_b32 s84, s86, 2
  s_add_u32 s86, s86, s56
  s_mul_i32 s87, s55, 22
  s_cmp_eq_u32 s55, 3
  s_cselect_b32 s69, 1, 0
  s_sub_u32 s87, s87, s69
  v_lshrrev_b32 v21, 3, v1
  s_lshl_b32 s69, s56, 3
  v_add_u32 v21, s69, v21
  v_bfe_u32 v22, v21, 1, 1
  v_lshlrev_b32 v22, 2, v22
  v_and_b32 v23, 7, v1
  v_xor_b32 v22, v22, v23
  v_lshlrev_b32 v22, 4, v22
  v_lshlrev_b32 v21, 10, v21
  v_add_u32 v21, v21, v22
  s_lshl_b32 s69, s85, 7
  v_add_u32 v27, s69, v21
  s_mul_i32 s3, s85, 11
  s_lshr_b32 s3, s3, 2
  s_cmp_ge_u32 s55, 2
  s_cselect_b32 s4, 21, 22
  s_mov_b32 s5, s85
  v_and_b32 v21, 31, v1
  s_lshl_b32 s69, s55, 5
  v_add_u32 v21, s69, v21
  v_lshrrev_b32 v22, 1, v21
  v_and_b32 v22, 7, v22
  v_lshrrev_b32 v23, 5, v1
  v_xor_b32 v22, v22, v23
  v_lshlrev_b32 v22, 4, v22
  v_lshlrev_b32 v21, 7, v21
  v_add_u32 v21, v21, v22
  s_lshl_b32 s69, s101, 6
  v_xor_b32 v21, s69, v21
  v_xor_b32 v8, 0, v21
  v_xor_b32 v9, 32, v21
  v_xor_b32 v10, 64, v21
  v_xor_b32 v11, 96, v21
  v_add_u32 v8, 113280, v8
  v_add_u32 v9, 113280, v9
  v_add_u32 v10, 113280, v10
  v_add_u32 v11, 113280, v11
  v_lshrrev_b32 v21, 4, v1
  v_and_b32 v22, 1, v21
  v_mul_u32_u24 v22, 11392, v22
  v_lshrrev_b32 v21, 1, v21
  v_lshlrev_b32 v21, 3, v21
  v_bfe_u32 v23, v1, 2, 2
  v_add_u32 v21, v21, v23
  v_mul_u32_u24 v21, 352, v21
  v_add_u32 v22, v22, v21
  v_and_b32 v23, 3, v1
  v_lshlrev_b32 v23, 3, v23
  v_add_u32 v22, v22, v23
  s_mul_i32 s69, s56, 192
  v_add_u32 v16, s69, v22
  v_add_u32 v17, 65536, v16
  v_and_b32 v21, 31, v1
  v_lshlrev_b32 v21, 2, v21
  s_mul_i32 s71, s81, 1408
  s_mul_i32 s70, s56, 768
  s_add_u32 s71, s71, s70
  s_add_u32 s71, s71, 8458240
  v_add_u32 v251, s71, v21
  s_lshl_b32 s70, s55, 7
  v_add_u32 v246, s70, v251
  v_add_u32 v247, 512, v246
  s_lshl_b32 s70, s57, 2
  s_add_u32 s70, s70, s55
  s_lshl_b32 s70, s70, 7
  s_add_u32 s70, s70, 8480768
  v_add_u32 v248, s70, v21
  s_add_u32 s70, s81, 0
  s_lshl_b32 s70, s70, 7
  s_add_u32 s70, s70, 8497152
  v_mov_b32 v249, s70
  s_add_u32 s70, s57, 24
  s_lshl_b32 s70, s70, 7
  s_add_u32 s70, s70, 8497152
  v_mov_b32 v250, s70
  v_lshrrev_b32 v21, 5, v1
  v_lshlrev_b32 v21, 2, v21
  v_bfe_u32 v23, v1, 2, 2
  v_add_u32 v21, v21, v23
  v_lshlrev_b32 v21, 7, v21
  v_lshrrev_b32 v23, 1, v23
  v_lshlrev_b32 v23, 6, v23
  v_add_u32 v21, v21, v23
  v_bfe_u32 v23, v1, 4, 1
  v_lshlrev_b32 v23, 5, v23
  v_add_u32 v21, v21, v23
  v_and_b32 v23, 3, v1
  v_lshlrev_b32 v23, 3, v23
  v_add_u32 v21, v21, v23
  s_lshl_b32 s69, s55, 11
  v_add_u32 v12, s69, v21
  v_xor_b32 v13, 64, v12
  v_add_u32 v14, 65536, v12
  v_add_u32 v15, 65536, v13
  v_add_u32 v18, 131072, v12
  v_add_u32 v19, 131072, v13
  v_mov_b32 v96, 0
  v_mov_b32 v97, 0
  v_mov_b32 v98, 0
  v_mov_b32 v99, 0
  v_mov_b32 v100, 0
  v_mov_b32 v101, 0
  v_mov_b32 v102, 0
  v_mov_b32 v103, 0
  v_mov_b32 v104, 0
  v_mov_b32 v105, 0
  v_mov_b32 v106, 0
  v_mov_b32 v107, 0
  v_mov_b32 v108, 0
  v_mov_b32 v109, 0
  v_mov_b32 v110, 0
  v_mov_b32 v111, 0
  v_mov_b32 v112, 0
  v_mov_b32 v113, 0
  v_mov_b32 v114, 0
  v_mov_b32 v115, 0
  v_mov_b32 v116, 0
  v_mov_b32 v117, 0
  v_mov_b32 v118, 0
  v_mov_b32 v119, 0
  v_mov_b32 v120, 0
  v_mov_b32 v121, 0
  v_mov_b32 v122, 0
  v_mov_b32 v123, 0
  v_mov_b32 v124, 0
  v_mov_b32 v125, 0
  v_mov_b32 v126, 0
  v_mov_b32 v127, 0
  v_mov_b32 v128, 0
  v_mov_b32 v129, 0
  v_mov_b32 v130, 0
  v_mov_b32 v131, 0
  v_mov_b32 v132, 0
  v_mov_b32 v133, 0
  v_mov_b32 v134, 0
  v_mov_b32 v135, 0
  v_mov_b32 v136, 0
  v_mov_b32 v137, 0
  v_mov_b32 v138, 0
  v_mov_b32 v139, 0
  v_mov_b32 v140, 0
  v_mov_b32 v141, 0
  v_mov_b32 v142, 0
  v_mov_b32 v143, 0
  v_mov_b32 v144, 0
  v_mov_b32 v145, 0
  v_mov_b32 v146, 0
  v_mov_b32 v147, 0
  v_mov_b32 v148, 0
  v_mov_b32 v149, 0
  v_mov_b32 v150, 0
  v_mov_b32 v151, 0
  v_mov_b32 v152, 0
  v_mov_b32 v153, 0
  v_mov_b32 v154, 0
  v_mov_b32 v155, 0
  v_mov_b32 v156, 0
  v_mov_b32 v157, 0
  v_mov_b32 v158, 0
  v_mov_b32 v159, 0
  v_mov_b32 v160, 0
  v_mov_b32 v161, 0
  v_mov_b32 v162, 0
  v_mov_b32 v163, 0
  v_mov_b32 v164, 0
  v_mov_b32 v165, 0
  v_mov_b32 v166, 0
  v_mov_b32 v167, 0
  v_mov_b32 v168, 0
  v_mov_b32 v169, 0
  v_mov_b32 v170, 0
  v_mov_b32 v171, 0
  v_mov_b32 v172, 0
  v_mov_b32 v173, 0
  v_mov_b32 v174, 0
  v_mov_b32 v175, 0
  v_mov_b32 v176, 0
  v_mov_b32 v177, 0
  v_mov_b32 v178, 0
  v_mov_b32 v179, 0
  v_mov_b32 v180, 0
  v_mov_b32 v181, 0
  v_mov_b32 v182, 0
  v_mov_b32 v183, 0
  v_mov_b32 v184, 0
  v_mov_b32 v185, 0
  v_mov_b32 v186, 0
  v_mov_b32 v187, 0
  v_mov_b32 v188, 0
  v_mov_b32 v189, 0
  v_mov_b32 v190, 0
  v_mov_b32 v191, 0
  s_bfe_u32 s89, s63, 262148
  s_mul_i32 s89, s89, 176128
  s_add_u32 s89, s89, s64
  s_add_u32 m0, s75, 45312
  s_nop 0
  buffer_load_dwordx4 v5, s[36:39], s89 offen lds
  s_add_u32 m0, s76, 45312
  s_nop 0
  buffer_load_dwordx4 v6, s[40:43], s89 offen lds
  s_and_b32 s74, s79, 45312
  s_add_u32 m0, s74, s77
  s_nop 0
  buffer_load_dwordx4 v7, s[44:47], s89 offen lds
  s_bfe_u32 s90, s63, 262148
  s_mul_i32 s90, s90, 176128
  s_add_u32 s90, s90, s65
  s_add_u32 m0, s75, 67968
  s_nop 0
  buffer_load_dwordx4 v5, s[36:39], s90 offen lds
  s_add_u32 m0, s76, 67968
  s_nop 0
  buffer_load_dwordx4 v6, s[40:43], s90 offen lds
  s_and_b32 s74, s79, 67968
  s_add_u32 m0, s74, s77
  s_nop 0
  buffer_load_dwordx4 v7, s[44:47], s90 offen lds
  v_mov_b32 v192, 0x3f803f80
  v_mov_b32 v193, 0x3f803f80
  v_mov_b32 v194, 0x3f803f80
  v_mov_b32 v195, 0x3f803f80
  s_sub_u32 s97, 2, s56
  s_lshl_b32 s98, s55, 11
  s_lshl_b32 s69, s56, 10
  s_add_u32 s98, s98, s69
  s_cmp_eq_u32 s56, 1
  s_cselect_b64 vcc, -1, 0
  s_waitcnt vmcnt(9)
  s_barrier
  s_bfe_u32 s88, s63, 262148
  s_lshl_b32 s88, s88, 7
  s_add_u32 s88, s88, s66
  s_add_u32 m0, s78, 129664
  s_nop 0
  buffer_load_dwordx4 v3, s[32:35], s88 offen lds
  s_add_u32 m0, s78, 137856
  s_nop 0
  buffer_load_dwordx4 v4, s[32:35], s88 offen lds
  ds_read_b64_tr_b16 v[40:41], v16 offset:0
  ds_read_b64_tr_b16 v[42:43], v16 offset:1408
  ds_read_b64_tr_b16 v[44:45], v16 offset:32
  ds_read_b64_tr_b16 v[46:47], v16 offset:1440
  ds_read_b64_tr_b16 v[48:49], v16 offset:64
  ds_read_b64_tr_b16 v[50:51], v16 offset:1472
  ds_read_b64_tr_b16 v[52:53], v16 offset:96
  ds_read_b64_tr_b16 v[54:55], v16 offset:1504
  ds_read_b64_tr_b16 v[56:57], v16 offset:128
  ds_read_b64_tr_b16 v[58:59], v16 offset:1536
  s_cbranch_vccnz L_u6_17
  ds_read_b64_tr_b16 v[60:61], v16 offset:160
  ds_read_b64_tr_b16 v[62:63], v16 offset:1568
L_u6_17:
  ds_read_b128 v[32:35], v8 offset:0
  ds_read_b64_tr_b16 v[64:65], v16 offset:5632
  ds_read_b64_tr_b16 v[66:67], v16 offset:7040
  ds_read_b64_tr_b16 v[68:69], v16 offset:5664
  ds_read_b64_tr_b16 v[70:71], v16 offset:7072
  ds_read_b64_tr_b16 v[72:73], v16 offset:5696
  ds_read_b64_tr_b16 v[74:75], v16 offset:7104
  ds_read_b64_tr_b16 v[76:77], v16 offset:5728
  ds_read_b64_tr_b16 v[78:79], v16 offset:7136
  ds_read_b64_tr_b16 v[80:81], v16 offset:5760
  ds_read_b64_tr_b16 v[82:83], v16 offset:7168
  s_cbranch_vccnz L_u6_18
  ds_read_b64_tr_b16 v[84:85], v16 offset:5792
  ds_read_b64_tr_b16 v[86:87], v16 offset:7200
L_u6_18:
  ds_read_b128 v[36:39], v9 offset:0
  s_waitcnt vmcnt(8) lgkmcnt(11)
  s_barrier
  v_mfma_f32_32x32x16_bf16 v[96:111], v[40:43], v[32:35], v[96:111]
  ds_read_b64_tr_b16 v[40:41], v16 offset:22656
  ds_read_b64_tr_b16 v[42:43], v16 offset:24064
  s_bfe_u32 s88, s63, 262152
  s_lshl_b32 s88, s88, 7
  s_add_u32 s88, s88, s66
  s_add_u32 m0, s78, 146048
  s_nop 0
  buffer_load_dwordx4 v3, s[32:35], s88 offen lds
  v_mfma_f32_32x32x16_bf16 v[112:127], v[44:47], v[32:35], v[112:127]
  ds_read_b64_tr_b16 v[44:45], v16 offset:22688
  ds_read_b64_tr_b16 v[46:47], v16 offset:24096
  v_mfma_f32_32x32x16_bf16 v[128:143], v[48:51], v[32:35], v[128:143]
  ds_read_b64_tr_b16 v[48:49], v16 offset:22720
  ds_read_b64_tr_b16 v[50:51], v16 offset:24128
  v_mfma_f32_32x32x16_bf16 v[144:159], v[52:55], v[32:35], v[144:159]
  ds_read_b64_tr_b16 v[52:53], v16 offset:22752
  ds_read_b64_tr_b16 v[54:55], v16 offset:24160
  s_add_u32 m0, s78, 154240
  s_nop 0
  buffer_load_dwordx4 v4, s[32:35], s88 offen lds
  v_mfma_f32_32x32x16_bf16 v[160:175], v[56:59], v[32:35], v[160:175]
  ds_read_b64_tr_b16 v[56:57], v16 offset:22784
  ds_read_b64_tr_b16 v[58:59], v16 offset:24192
  s_cbranch_vccnz L_u6_19
  v_mfma_f32_32x32x16_bf16 v[176:191], v[60:63], v[32:35], v[176:191]
  ds_read_b64_tr_b16 v[60:61], v16 offset:22816
  ds_read_b64_tr_b16 v[62:63], v16 offset:24224
L_u6_19:
  ds_read_b128 v[32:35], v10 offset:0
  s_waitcnt lgkmcnt(11)
  v_mfma_f32_32x32x16_bf16 v[96:111], v[64:67], v[36:39], v[96:111]
  ds_read_b64_tr_b16 v[64:65], v16 offset:28288
  ds_read_b64_tr_b16 v[66:67], v16 offset:29696
  s_bfe_u32 s89, s63, 262152
  s_mul_i32 s89, s89, 176128
  s_add_u32 s89, s89, s64
  s_add_u32 m0, s75, 90624
  s_nop 0
  buffer_load_dwordx4 v5, s[36:39], s89 offen lds
  v_mfma_f32_32x32x16_bf16 v[112:127], v[68:71], v[36:39], v[112:127]
  ds_read_b64_tr_b16 v[68:69], v16 offset:28320
  ds_read_b64_tr_b16 v[70:71], v16 offset:29728
  v_mfma_f32_32x32x16_bf16 v[128:143], v[72:75], v[36:39], v[128:143]
  ds_read_b64_tr_b16 v[72:73], v16 offset:28352
  ds_read_b64_tr_b16 v[74:75], v16 offset:29760
  v_mfma_f32_32x32x16_bf16 v[144:159], v[76:79], v[36:39], v[144:159]
  ds_read_b64_tr_b16 v[76:77], v16 offset:28384
  ds_read_b64_tr_b16 v[78:79], v16 offset:29792
  s_add_u32 m0, s76, 90624
  s_nop 0
  buffer_load_dwordx4 v6, s[40:43], s89 offen lds
  v_mfma_f32_32x32x16_bf16 v[160:175], v[80:83], v[36:39], v[160:175]
  ds_read_b64_tr_b16 v[80:81], v16 offset:28416
  ds_read_b64_tr_b16 v[82:83], v16 offset:29824
  s_cbranch_vccnz L_u6_20
  v_mfma_f32_32x32x16_bf16 v[176:191], v[84:87], v[36:39], v[176:191]
  ds_read_b64_tr_b16 v[84:85], v16 offset:28448
  ds_read_b64_tr_b16 v[86:87], v16 offset:29856
L_u6_20:
  ds_read_b128 v[36:39], v11 offset:0
  s_waitcnt vmcnt(4) lgkmcnt(11)
  s_barrier
  v_mfma_f32_32x32x16_bf16 v[96:111], v[40:43], v[32:35], v[96:111]
  ds_read_b64_tr_b16 v[40:41], v16 offset:45312
  ds_read_b64_tr_b16 v[42:43], v16 offset:46720
  s_and_b32 s74, s79, 90624
  s_add_u32 m0, s74, s77
  s_nop 0
  buffer_load_dwordx4 v7, s[44:47], s89 offen lds
  v_mfma_f32_32x32x16_bf16 v[112:127], v[44:47], v[32:35], v[112:127]
  ds_read_b64_tr_b16 v[44:45], v16 offset:45344
  ds_read_b64_tr_b16 v[46:47], v16 offset:46752
  v_mfma_f32_32x32x16_bf16 v[128:143], v[48:51], v[32:35], v[128:143]
  ds_read_b64_tr_b16 v[48:49], v16 offset:45376
  ds_read_b64_tr_b16 v[50:51], v16 offset:46784
  s_bfe_u32 s90, s63, 262152
  s_mul_i32 s90, s90, 176128
  s_add_u32 s90, s90, s65
  s_add_u32 m0, s75, 0
  s_nop 0
  buffer_load_dwordx4 v5, s[36:39], s90 offen lds
  v_mfma_f32_32x32x16_bf16 v[144:159], v[52:55], v[32:35], v[144:159]
  ds_read_b64_tr_b16 v[52:53], v16 offset:45408
  ds_read_b64_tr_b16 v[54:55], v16 offset:46816
  v_mfma_f32_32x32x16_bf16 v[160:175], v[56:59], v[32:35], v[160:175]
  ds_read_b64_tr_b16 v[56:57], v16 offset:45440
  ds_read_b64_tr_b16 v[58:59], v16 offset:46848
  global_load_dword v25, v2, s[26:27] sc1
  s_cbranch_vccnz L_u6_21
  v_mfma_f32_32x32x16_bf16 v[176:191], v[60:63], v[32:35], v[176:191]
  ds_read_b64_tr_b16 v[60:61], v16 offset:45472
  ds_read_b64_tr_b16 v[62:63], v16 offset:46880
L_u6_21:
  ds_read_b128 v[32:35], v8 offset:16384
  s_waitcnt lgkmcnt(11)
  v_mfma_f32_32x32x16_bf16 v[96:111], v[64:67], v[36:39], v[96:111]
  ds_read_b64_tr_b16 v[64:65], v16 offset:50944
  ds_read_b64_tr_b16 v[66:67], v16 offset:52352
  s_add_u32 m0, s76, 0
  s_nop 0
  buffer_load_dwordx4 v6, s[40:43], s90 offen lds
  v_mfma_f32_32x32x16_bf16 v[112:127], v[68:71], v[36:39], v[112:127]
  ds_read_b64_tr_b16 v[68:69], v16 offset:50976
  ds_read_b64_tr_b16 v[70:71], v16 offset:52384
  v_mfma_f32_32x32x16_bf16 v[128:143], v[72:75], v[36:39], v[128:143]
  ds_read_b64_tr_b16 v[72:73], v16 offset:51008
  ds_read_b64_tr_b16 v[74:75], v16 offset:52416
  v_mfma_f32_32x32x16_bf16 v[144:159], v[76:79], v[36:39], v[144:159]
  ds_read_b64_tr_b16 v[76:77], v16 offset:51040
  ds_read_b64_tr_b16 v[78:79], v16 offset:52448
  s_and_b32 s74, s79, 0
  s_add_u32 m0, s74, s77
  s_nop 0
  buffer_load_dwordx4 v7, s[44:47], s90 offen lds
  v_mfma_f32_32x32x16_bf16 v[160:175], v[80:83], v[36:39], v[160:175]
  ds_read_b64_tr_b16 v[80:81], v16 offset:51072
  ds_read_b64_tr_b16 v[82:83], v16 offset:52480
  s_cbranch_vccnz L_u6_22
  v_mfma_f32_32x32x16_bf16 v[176:191], v[84:87], v[36:39], v[176:191]
  ds_read_b64_tr_b16 v[84:85], v16 offset:51104
  ds_read_b64_tr_b16 v[86:87], v16 offset:52512
L_u6_22:
  ds_read_b128 v[36:39], v9 offset:16384
  s_waitcnt vmcnt(11) lgkmcnt(11)
  s_barrier
  v_mfma_f32_32x32x16_bf16 v[96:111], v[40:43], v[32:35], v[96:111]
  s_cmp_eq_u32 s55, 0
  s_cbranch_scc0 L_cs_23
  v_mfma_f32_32x32x16_bf16 v[208:223], v[192:195], v[40:43], 0
L_cs_23:
  ds_read_b64_tr_b16 v[40:41], v17 offset:2432
  ds_read_b64_tr_b16 v[42:43], v17 offset:3840
  s_bfe_u32 s88, s63, 262156
  s_lshl_b32 s88, s88, 7
  s_add_u32 s88, s88, s66
  s_add_u32 m0, s78, 113280
  s_nop 0
  buffer_load_dwordx4 v3, s[32:35], s88 offen lds
  v_mfma_f32_32x32x16_bf16 v[112:127], v[44:47], v[32:35], v[112:127]
  s_cmp_eq_u32 s55, 1
  s_cbranch_scc0 L_cs_24
  s_nop 0
  v_mfma_f32_32x32x16_bf16 v[208:223], v[192:195], v[44:47], 0
L_cs_24:
  ds_read_b64_tr_b16 v[44:45], v17 offset:2464
  ds_read_b64_tr_b16 v[46:47], v17 offset:3872
  v_mfma_f32_32x32x16_bf16 v[128:143], v[48:51], v[32:35], v[128:143]
  s_cmp_eq_u32 s55, 2
  s_cbranch_scc0 L_cs_25
  s_nop 6
  v_mfma_f32_32x32x16_bf16 v[208:223], v[192:195], v[48:51], 0
L_cs_25:
  ds_read_b64_tr_b16 v[48:49], v17 offset:2496
  ds_read_b64_tr_b16 v[50:51], v17 offset:3904
  v_mfma_f32_32x32x16_bf16 v[144:159], v[52:55], v[32:35], v[144:159]
  s_cmp_eq_u32 s55, 3
  s_cbranch_scc0 L_cs_26
  s_nop 6
  v_mfma_f32_32x32x16_bf16 v[208:223], v[192:195], v[52:55], 0
L_cs_26:
  ds_read_b64_tr_b16 v[52:53], v17 offset:2528
  ds_read_b64_tr_b16 v[54:55], v17 offset:3936
  s_add_u32 m0, s78, 121472
  s_nop 0
  buffer_load_dwordx4 v4, s[32:35], s88 offen lds
  v_mfma_f32_32x32x16_bf16 v[160:175], v[56:59], v[32:35], v[160:175]
  s_cmp_eq_u32 s55, 0
  s_cbranch_scc0 L_cs_27
  v_mfma_f32_32x32x16_bf16 v[224:239], v[192:195], v[56:59], 0
L_cs_27:
  ds_read_b64_tr_b16 v[56:57], v17 offset:2560
  ds_read_b64_tr_b16 v[58:59], v17 offset:3968
  s_cbranch_vccnz L_u6_29
  v_mfma_f32_32x32x16_bf16 v[176:191], v[60:63], v[32:35], v[176:191]
  s_cmp_eq_u32 s55, 1
  s_cbranch_scc0 L_cs_28
  s_nop 5
  v_mfma_f32_32x32x16_bf16 v[224:239], v[192:195], v[60:63], 0
L_cs_28:
  ds_read_b64_tr_b16 v[60:61], v17 offset:2592
  ds_read_b64_tr_b16 v[62:63], v17 offset:4000
L_u6_29:
  ds_read_b128 v[32:35], v10 offset:16384
  s_waitcnt lgkmcnt(11)
  v_mfma_f32_32x32x16_bf16 v[96:111], v[64:67], v[36:39], v[96:111]
  s_cmp_eq_u32 s55, 0
  s_cbranch_scc0 L_cs_30
  v_mfma_f32_32x32x16_bf16 v[208:223], v[192:195], v[64:67], v[208:223]
L_cs_30:
  ds_read_b64_tr_b16 v[64:65], v17 offset:8064
  ds_read_b64_tr_b16 v[66:67], v17 offset:9472
  s_bfe_u32 s89, s63, 262156
  s_mul_i32 s89, s89, 176128
  s_add_u32 s89, s89, s64
  s_add_u32 m0, s75, 22656
  s_nop 0
  buffer_load_dwordx4 v5, s[36:39], s89 offen lds
  v_mfma_f32_32x32x16_bf16 v[112:127], v[68:71], v[36:39], v[112:127]
  s_cmp_eq_u32 s55, 1
  s_cbranch_scc0 L_cs_31
  v_mfma_f32_32x32x16_bf16 v[208:223], v[192:195], v[68:71], v[208:223]
L_cs_31:
  ds_read_b64_tr_b16 v[68:69], v17 offset:8096
  ds_read_b64_tr_b16 v[70:71], v17 offset:9504
  v_mfma_f32_32x32x16_bf16 v[128:143], v[72:75], v[36:39], v[128:143]
  s_cmp_eq_u32 s55, 2
  s_cbranch_scc0 L_cs_32
  v_mfma_f32_32x32x16_bf16 v[208:223], v[192:195], v[72:75], v[208:223]
L_cs_32:
  ds_read_b64_tr_b16 v[72:73], v17 offset:8128
  ds_read_b64_tr_b16 v[74:75], v17 offset:9536
  v_mfma_f32_32x32x16_bf16 v[144:159], v[76:79], v[36:39], v[144:159]
  s_cmp_eq_u32 s55, 3
  s_cbranch_scc0 L_cs_33
  v_mfma_f32_32x32x16_bf16 v[208:223], v[192:195], v[76:79], v[208:223]
L_cs_33:
  ds_read_b64_tr_b16 v[76:77], v17 offset:8160
  ds_read_b64_tr_b16 v[78:79], v17 offset:9568
  s_add_u32 m0, s76, 22656
  s_nop 0
  buffer_load_dwordx4 v6, s[40:43], s89 offen lds
  v_mfma_f32_32x32x16_bf16 v[160:175], v[80:83], v[36:39], v[160:175]
  s_cmp_eq_u32 s55, 0
  s_cbranch_scc0 L_cs_34
  v_mfma_f32_32x32x16_bf16 v[224:239], v[192:195], v[80:83], v[224:239]
L_cs_34:
  ds_read_b64_tr_b16 v[80:81], v17 offset:8192
  ds_read_b64_tr_b16 v[82:83], v17 offset:9600
  s_cbranch_vccnz L_u6_36
  v_mfma_f32_32x32x16_bf16 v[176:191], v[84:87], v[36:39], v[176:191]
  s_cmp_eq_u32 s55, 1
  s_cbranch_scc0 L_cs_35
  v_mfma_f32_32x32x16_bf16 v[224:239], v[192:195], v[84:87], v[224:239]
L_cs_35:
  ds_read_b64_tr_b16 v[84:85], v17 offset:8224
  ds_read_b64_tr_b16 v[86:87], v17 offset:9632
L_u6_36:
  ds_read_b128 v[36:39], v11 offset:16384
  s_waitcnt vmcnt(8) lgkmcnt(11)
  s_barrier
  v_mfma_f32_32x32x16_bf16 v[96:111], v[40:43], v[32:35], v[96:111]
  ds_read_b64_tr_b16 v[40:41], v17 offset:25088
  ds_read_b64_tr_b16 v[42:43], v17 offset:26496
  s_and_b32 s74, s79, 22656
  s_add_u32 m0, s74, s77
  s_nop 0
  buffer_load_dwordx4 v7, s[44:47], s89 offen lds
  v_mfma_f32_32x32x16_bf16 v[112:127], v[44:47], v[32:35], v[112:127]
  ds_read_b64_tr_b16 v[44:45], v17 offset:25120
  ds_read_b64_tr_b16 v[46:47], v17 offset:26528
  v_mfma_f32_32x32x16_bf16 v[128:143], v[48:51], v[32:35], v[128:143]
  ds_read_b64_tr_b16 v[48:49], v17 offset:25152
  ds_read_b64_tr_b16 v[50:51], v17 offset:26560
  v_mfma_f32_32x32x16_bf16 v[144:159], v[52:55], v[32:35], v[144:159]
  ds_read_b64_tr_b16 v[52:53], v17 offset:25184
  ds_read_b64_tr_b16 v[54:55], v17 offset:26592
  s_bfe_u32 s90, s63, 262156
  s_mul_i32 s90, s90, 176128
  s_add_u32 s90, s90, s65
  s_add_u32 m0, s75, 45312
  s_nop 0
  buffer_load_dwordx4 v5, s[36:39], s90 offen lds
  v_mfma_f32_32x32x16_bf16 v[160:175], v[56:59], v[32:35], v[160:175]
  ds_read_b64_tr_b16 v[56:57], v17 offset:25216
  ds_read_b64_tr_b16 v[58:59], v17 offset:26624
  s_cbranch_vccnz L_u6_37
  v_mfma_f32_32x32x16_bf16 v[176:191], v[60:63], v[32:35], v[176:191]
  ds_read_b64_tr_b16 v[60:61], v17 offset:25248
  ds_read_b64_tr_b16 v[62:63], v17 offset:26656
L_u6_37:
  ds_read_b128 v[32:35], v8 offset:32768
  s_waitcnt lgkmcnt(11)
  v_mfma_f32_32x32x16_bf16 v[96:111], v[64:67], v[36:39], v[96:111]
  ds_read_b64_tr_b16 v[64:65], v17 offset:30720
  ds_read_b64_tr_b16 v[66:67], v17 offset:32128
  s_add_u32 m0, s76, 45312
  s_nop 0
  buffer_load_dwordx4 v6, s[40:43], s90 offen lds
  v_mfma_f32_32x32x16_bf16 v[112:127], v[68:71], v[36:39], v[112:127]
  ds_read_b64_tr_b16 v[68:69], v17 offset:30752
  ds_read_b64_tr_b16 v[70:71], v17 offset:32160
  v_mfma_f32_32x32x16_bf16 v[128:143], v[72:75], v[36:39], v[128:143]
  ds_read_b64_tr_b16 v[72:73], v17 offset:30784
  ds_read_b64_tr_b16 v[74:75], v17 offset:32192
  v_mfma_f32_32x32x16_bf16 v[144:159], v[76:79], v[36:39], v[144:159]
  ds_read_b64_tr_b16 v[76:77], v17 offset:30816
  ds_read_b64_tr_b16 v[78:79], v17 offset:32224
  s_and_b32 s74, s79, 45312
  s_add_u32 m0, s74, s77
  s_nop 0
  buffer_load_dwordx4 v7, s[44:47], s90 offen lds
  v_mfma_f32_32x32x16_bf16 v[160:175], v[80:83], v[36:39], v[160:175]
  ds_read_b64_tr_b16 v[80:81], v17 offset:30848
  ds_read_b64_tr_b16 v[82:83], v17 offset:32256
  s_cbranch_vccnz L_u6_38
  v_mfma_f32_32x32x16_bf16 v[176:191], v[84:87], v[36:39], v[176:191]
  ds_read_b64_tr_b16 v[84:85], v17 offset:30880
  ds_read_b64_tr_b16 v[86:87], v17 offset:32288
L_u6_38:
  ds_read_b128 v[36:39], v9 offset:32768
  s_waitcnt vmcnt(8) lgkmcnt(11)
  s_barrier
  v_mfma_f32_32x32x16_bf16 v[96:111], v[40:43], v[32:35], v[96:111]
  ds_read_b64_tr_b16 v[40:41], v16 offset:0
  ds_read_b64_tr_b16 v[42:43], v16 offset:1408
  s_waitcnt vmcnt(10)
  v_readfirstlane_b32 s69, v25
  s_nop 1
  s_cmp_lt_u32 s69, 32
  s_cbranch_scc1 L_slow_ini_f
L_back_ini_f:
  v_mfma_f32_32x32x16_bf16 v[112:127], v[44:47], v[32:35], v[112:127]
  ds_read_b64_tr_b16 v[44:45], v16 offset:32
  ds_read_b64_tr_b16 v[46:47], v16 offset:1440
  s_mov_b32 exec_hi, 0
  buffer_atomic_add_f32 v208, v246, s[48:51], 0 offen
  s_cmp_lt_u32 s55, s97
  s_cbranch_scc0 L_pub_40
  buffer_atomic_add_f32 v224, v247, s[48:51], 0 offen
L_pub_40:
  s_mov_b32 exec_hi, -1
  v_mfma_f32_32x32x16_bf16 v[128:143], v[48:51], v[32:35], v[128:143]
  ds_read_b64_tr_b16 v[48:49], v16 offset:64
  ds_read_b64_tr_b16 v[50:51], v16 offset:1472
  v_mfma_f32_32x32x16_bf16 v[144:159], v[52:55], v[32:35], v[144:159]
  ds_read_b64_tr_b16 v[52:53], v16 offset:96
  ds_read_b64_tr_b16 v[54:55], v16 offset:1504
  s_bfe_u32 s88, s63, 262160
  s_lshl_b32 s88, s88, 7
  s_add_u32 s88, s88, s66
  s_add_u32 m0, s78, 129664
  s_nop 0
  buffer_load_dwordx4 v3, s[32:35], s88 offen lds
  v_mfma_f32_32x32x16_bf16 v[160:175], v[56:59], v[32:35], v[160:175]
  ds_read_b64_tr_b16 v[56:57], v16 offset:128
  ds_read_b64_tr_b16 v[58:59], v16 offset:1536
  s_add_u32 m0, s78, 137856
  s_nop 0
  buffer_load_dwordx4 v4, s[32:35], s88 offen lds
  s_cbranch_vccnz L_u6_41
  v_mfma_f32_32x32x16_bf16 v[176:191], v[60:63], v[32:35], v[176:191]
  ds_read_b64_tr_b16 v[60:61], v16 offset:160
  ds_read_b64_tr_b16 v[62:63], v16 offset:1568
L_u6_41:
  ds_read_b128 v[32:35], v10 offset:32768
  s_waitcnt lgkmcnt(11)
  v_mfma_f32_32x32x16_bf16 v[96:111], v[64:67], v[36:39], v[96:111]
  ds_read_b64_tr_b16 v[64:65], v16 offset:5632
  ds_read_b64_tr_b16 v[66:67], v16 offset:7040
  s_bfe_u32 s89, s63, 262160
  s_mul_i32 s89, s89, 176128
  s_add_u32 s89, s89, s64
  s_add_u32 m0, s75, 67968
  s_nop 0
  buffer_load_dwordx4 v5, s[36:39], s89 offen lds
  v_mfma_f32_32x32x16_bf16 v[112:127], v[68:71], v[36:39], v[112:127]
  ds_read_b64_tr_b16 v[68:69], v16 offset:5664
  ds_read_b64_tr_b16 v[70:71], v16 offset:7072
  v_mfma_f32_32x32x16_bf16 v[128:143], v[72:75], v[36:39], v[128:143]
  ds_read_b64_tr_b16 v[72:73], v16 offset:5696
  ds_read_b64_tr_b16 v[74:75], v16 offset:7104
  v_mfma_f32_32x32x16_bf16 v[144:159], v[76:79], v[36:39], v[144:159]
  ds_read_b64_tr_b16 v[76:77], v16 offset:5728
  ds_read_b64_tr_b16 v[78:79], v16 offset:7136
  s_add_u32 m0, s76, 67968
  s_nop 0
  buffer_load_dwordx4 v6, s[40:43], s89 offen lds
  v_mfma_f32_32x32x16_bf16 v[160:175], v[80:83], v[36:39], v[160:175]
  ds_read_b64_tr_b16 v[80:81], v16 offset:5760
  ds_read_b64_tr_b16 v[82:83], v16 offset:7168
  s_cbranch_vccnz L_u6_42
  v_mfma_f32_32x32x16_bf16 v[176:191], v[84:87], v[36:39], v[176:191]
  ds_read_b64_tr_b16 v[84:85], v16 offset:5792
  ds_read_b64_tr_b16 v[86:87], v16 offset:7200
L_u6_42:
  ds_read_b128 v[36:39], v11 offset:32768
  s_waitcnt vmcnt(7) lgkmcnt(11)
  s_barrier
  v_mfma_f32_32x32x16_bf16 v[96:111], v[40:43], v[32:35], v[96:111]
  ds_read_b64_tr_b16 v[40:41], v16 offset:22656
  ds_read_b64_tr_b16 v[42:43], v16 offset:24064
  s_and_b32 s74, s79, 67968
  s_add_u32 m0, s74, s77
  s_nop 0
  buffer_load_dwordx4 v7, s[44:47], s89 offen lds
  v_mfma_f32_32x32x16_bf16 v[112:127], v[44:47], v[32:35], v[112:127]
  ds_read_b64_tr_b16 v[44:45], v16 offset:22688
  ds_read_b64_tr_b16 v[46:47], v16 offset:24096
  v_mfma_f32_32x32x16_bf16 v[128:143], v[48:51], v[32:35], v[128:143]
  ds_read_b64_tr_b16 v[48:49], v16 offset:22720
  ds_read_b64_tr_b16 v[50:51], v16 offset:24128
  v_mfma_f32_32x32x16_bf16 v[144:159], v[52:55], v[32:35], v[144:159]
  ds_read_b64_tr_b16 v[52:53], v16 offset:22752
  ds_read_b64_tr_b16 v[54:55], v16 offset:24160
  s_bfe_u32 s90, s63, 262160
  s_mul_i32 s90, s90, 176128
  s_add_u32 s90, s90, s65
  s_add_u32 m0, s75, 90624
  s_nop 0
  buffer_load_dwordx4 v5, s[36:39], s90 offen lds
  v_mfma_f32_32x32x16_bf16 v[160:175], v[56:59], v[32:35], v[160:175]
  ds_read_b64_tr_b16 v[56:57], v16 offset:22784
  ds_read_b64_tr_b16 v[58:59], v16 offset:24192
  s_cbranch_vccnz L_u6_43
  v_mfma_f32_32x32x16_bf16 v[176:191], v[60:63], v[32:35], v[176:191]
  ds_read_b64_tr_b16 v[60:61], v16 offset:22816
  ds_read_b64_tr_b16 v[62:63], v16 offset:24224
L_u6_43:
  ds_read_b128 v[32:35], v8 offset:0
  s_waitcnt lgkmcnt(11)
  v_mfma_f32_32x32x16_bf16 v[96:111], v[64:67], v[36:39], v[96:111]
  ds_read_b64_tr_b16 v[64:65], v16 offset:28288
  ds_read_b64_tr_b16 v[66:67], v16 offset:29696
  s_add_u32 m0, s76, 90624
  s_nop 0
  buffer_load_dwordx4 v6, s[40:43], s90 offen lds
  v_mfma_f32_32x32x16_bf16 v[112:127], v[68:71], v[36:39], v[112:127]
  ds_read_b64_tr_b16 v[68:69], v16 offset:28320
  ds_read_b64_tr_b16 v[70:71], v16 offset:29728
  v_mfma_f32_32x32x16_bf16 v[128:143], v[72:75], v[36:39], v[128:143]
  ds_read_b64_tr_b16 v[72:73], v16 offset:28352
  ds_read_b64_tr_b16 v[74:75], v16 offset:29760
  v_mfma_f32_32x32x16_bf16 v[144:159], v[76:79], v[36:39], v[144:159]
  ds_read_b64_tr_b16 v[76:77], v16 offset:28384
  ds_read_b64_tr_b16 v[78:79], v16 offset:29792
  s_and_b32 s74, s79, 90624
  s_add_u32 m0, s74, s77
  s_nop 0
  buffer_load_dwordx4 v7, s[44:47], s90 offen lds
  v_mfma_f32_32x32x16_bf16 v[160:175], v[80:83], v[36:39], v[160:175]
  ds_read_b64_tr_b16 v[80:81], v16 offset:28416
  ds_read_b64_tr_b16 v[82:83], v16 offset:29824
  s_cbranch_vccnz L_u6_44
  v_mfma_f32_32x32x16_bf16 v[176:191], v[84:87], v[36:39], v[176:191]
  ds_read_b64_tr_b16 v[84:85], v16 offset:28448
  ds_read_b64_tr_b16 v[86:87], v16 offset:29856
L_u6_44:
  ds_read_b128 v[36:39], v9 offset:0
  s_waitcnt vmcnt(8) lgkmcnt(11)
  s_barrier
  v_mfma_f32_32x32x16_bf16 v[96:111], v[40:43], v[32:35], v[96:111]
  ds_read_b64_tr_b16 v[40:41], v16 offset:45312
  ds_read_b64_tr_b16 v[42:43], v16 offset:46720
  s_bfe_u32 s88, s63, 262164
  s_lshl_b32 s88, s88, 7
  s_add_u32 s88, s88, s66
  s_add_u32 m0, s78, 146048
  s_nop 0
  buffer_load_dwordx4 v3, s[32:35], s88 offen lds
  v_mfma_f32_32x32x16_bf16 v[112:127], v[44:47], v[32:35], v[112:127]
  ds_read_b64_tr_b16 v[44:45], v16 offset:45344
  ds_read_b64_tr_b16 v[46:47], v16 offset:46752
  v_mfma_f32_32x32x16_bf16 v[128:143], v[48:51], v[32:35], v[128:143]
  ds_read_b64_tr_b16 v[48:49], v16 offset:45376
  ds_read_b64_tr_b16 v[50:51], v16 offset:46784
  v_mfma_f32_32x32x16_bf16 v[144:159], v[52:55], v[32:35], v[144:159]
  ds_read_b64_tr_b16 v[52:53], v16 offset:45408
  ds_read_b64_tr_b16 v[54:55], v16 offset:46816
  s_add_u32 m0, s78, 154240
  s_nop 0
  buffer_load_dwordx4 v4, s[32:35], s88 offen lds
  v_mfma_f32_32x32x16_bf16 v[160:175], v[56:59], v[32:35], v[160:175]
  ds_read_b64_tr_b16 v[56:57], v16 offset:45440
  ds_read_b64_tr_b16 v[58:59], v16 offset:46848
  s_cbranch_vccnz L_u6_45
  v_mfma_f32_32x32x16_bf16 v[176:191], v[60:63], v[32:35], v[176:191]
  ds_read_b64_tr_b16 v[60:61], v16 offset:45472
  ds_read_b64_tr_b16 v[62:63], v16 offset:46880
L_u6_45:
  ds_read_b128 v[32:35], v10 offset:0
  s_waitcnt lgkmcnt(11)
  v_mfma_f32_32x32x16_bf16 v[96:111], v[64:67], v[36:39], v[96:111]
  ds_read_b64_tr_b16 v[64:65], v16 offset:50944
  ds_read_b64_tr_b16 v[66:67], v16 offset:52352
  s_bfe_u32 s89, s63, 262164
  s_mul_i32 s89, s89, 176128
  s_add_u32 s89, s89, s64
  s_add_u32 m0, s75, 0
  s_nop 0
  buffer_load_dwordx4 v5, s[36:39], s89 offen lds
  v_mfma_f32_32x32x16_bf16 v[112:127], v[68:71], v[36:39], v[112:127]
  ds_read_b64_tr_b16 v[68:69], v16 offset:50976
  ds_read_b64_tr_b16 v[70:71], v16 offset:52384
  v_mfma_f32_32x32x16_bf16 v[128:143], v[72:75], v[36:39], v[128:143]
  ds_read_b64_tr_b16 v[72:73], v16 offset:51008
  ds_read_b64_tr_b16 v[74:75], v16 offset:52416
  v_mfma_f32_32x32x16_bf16 v[144:159], v[76:79], v[36:39], v[144:159]
  ds_read_b64_tr_b16 v[76:77], v16 offset:51040
  ds_read_b64_tr_b16 v[78:79], v16 offset:52448
  s_add_u32 m0, s76, 0
  s_nop 0
  buffer_load_dwordx4 v6, s[40:43], s89 offen lds
  v_mfma_f32_32x32x16_bf16 v[160:175], v[80:83], v[36:39], v[160:175]
  ds_read_b64_tr_b16 v[80:81], v16 offset:51072
  ds_read_b64_tr_b16 v[82:83], v16 offset:52480
  s_cbranch_vccnz L_u6_46
  v_mfma_f32_32x32x16_bf16 v[176:191], v[84:87], v[36:39], v[176:191]
  ds_read_b64_tr_b16 v[84:85], v16 offset:51104
  ds_read_b64_tr_b16 v[86:87], v16 offset:52512
L_u6_46:
  ds_read_b128 v[36:39], v11 offset:0
  s_waitcnt vmcnt(7) lgkmcnt(11)
  s_barrier
  v_mfma_f32_32x32x16_bf16 v[96:111], v[40:43], v[32:35], v[96:111]
  ds_read_b64_tr_b16 v[40:41], v17 offset:2432
  ds_read_b64_tr_b16 v[42:43], v17 offset:3840
  s_cmp_eq_u32 s54, 0
  s_cbranch_scc0 L_sig_47
  v_mov_b32 v30, 1
  s_mov_b64 exec, 1
  buffer_atomic_add v30, v249, s[48:51], 0 offen
  s_mov_b64 exec, -1
L_sig_47:
  v_mfma_f32_32x32x16_bf16 v[112:127], v[44:47], v[32:35], v[112:127]
  ds_read_b64_tr_b16 v[44:45], v17 offset:2464
  ds_read_b64_tr_b16 v[46:47], v17 offset:3872
  v_mfma_f32_32x32x16_bf16 v[128:143], v[48:51], v[32:35], v[128:143]
  ds_read_b64_tr_b16 v[48:49], v17 offset:2496
  ds_read_b64_tr_b16 v[50:51], v17 offset:3904
  s_and_b32 s74, s79, 0
  s_add_u32 m0, s74, s77
  s_nop 0
  buffer_load_dwordx4 v7, s[44:47], s89 offen lds
  v_mfma_f32_32x32x16_bf16 v[144:159], v[52:55], v[32:35], v[144:159]
  ds_read_b64_tr_b16 v[52:53], v17 offset:2528
  ds_read_b64_tr_b16 v[54:55], v17 offset:3936
  v_mfma_f32_32x32x16_bf16 v[160:175], v[56:59], v[32:35], v[160:175]
  ds_read_b64_tr_b16 v[56:57], v17 offset:2560
  ds_read_b64_tr_b16 v[58:59], v17 offset:3968
  s_bfe_u32 s90, s63, 262164
  s_mul_i32 s90, s90, 176128
  s_add_u32 s90, s90, s65
  s_add_u32 m0, s75, 22656
  s_nop 0
  buffer_load_dwordx4 v5, s[36:39], s90 offen lds
  s_cbranch_vccnz L_u6_48
  v_mfma_f32_32x32x16_bf16 v[176:191], v[60:63], v[32:35], v[176:191]
  ds_read_b64_tr_b16 v[60:61], v17 offset:2592
  ds_read_b64_tr_b16 v[62:63], v17 offset:4000
L_u6_48:
  ds_read_b128 v[32:35], v8 offset:16384
  s_waitcnt lgkmcnt(11)
  v_mfma_f32_32x32x16_bf16 v[96:111], v[64:67], v[36:39], v[96:111]
  ds_read_b64_tr_b16 v[64:65], v17 offset:8064
  ds_read_b64_tr_b16 v[66:67], v17 offset:9472
  s_add_u32 m0, s76, 22656
  s_nop 0
  buffer_load_dwordx4 v6, s[40:43], s90 offen lds
  v_mfma_f32_32x32x16_bf16 v[112:127], v[68:71], v[36:39], v[112:127]
  ds_read_b64_tr_b16 v[68:69], v17 offset:8096
  ds_read_b64_tr_b16 v[70:71], v17 offset:9504
  v_mfma_f32_32x32x16_bf16 v[128:143], v[72:75], v[36:39], v[128:143]
  ds_read_b64_tr_b16 v[72:73], v17 offset:8128
  ds_read_b64_tr_b16 v[74:75], v17 offset:9536
  v_mfma_f32_32x32x16_bf16 v[144:159], v[76:79], v[36:39], v[144:159]
  ds_read_b64_tr_b16 v[76:77], v17 offset:8160
  ds_read_b64_tr_b16 v[78:79], v17 offset:9568
  s_and_b32 s74, s79, 22656
  s_add_u32 m0, s74, s77
  s_nop 0
  buffer_load_dwordx4 v7, s[44:47], s90 offen lds
  v_mfma_f32_32x32x16_bf16 v[160:175], v[80:83], v[36:39], v[160:175]
  ds_read_b64_tr_b16 v[80:81], v17 offset:8192
  ds_read_b64_tr_b16 v[82:83], v17 offset:9600
  s_cbranch_vccnz L_u6_49
  v_mfma_f32_32x32x16_bf16 v[176:191], v[84:87], v[36:39], v[176:191]
  ds_read_b64_tr_b16 v[84:85], v17 offset:8224
  ds_read_b64_tr_b16 v[86:87], v17 offset:9632
L_u6_49:
  ds_read_b128 v[36:39], v9 offset:16384
  s_waitcnt vmcnt(8) lgkmcnt(11)
  s_barrier
  v_mfma_f32_32x32x16_bf16 v[96:111], v[40:43], v[32:35], v[96:111]
  ds_read_b64_tr_b16 v[40:41], v17 offset:25088
  ds_read_b64_tr_b16 v[42:43], v17 offset:26496
  s_bfe_u32 s88, s63, 262168
  s_lshl_b32 s88, s88, 7
  s_add_u32 s88, s88, s66
  s_add_u32 m0, s78, 113280
  s_nop 0
  buffer_load_dwordx4 v3, s[32:35], s88 offen lds
  v_mfma_f32_32x32x16_bf16 v[112:127], v[44:47], v[32:35], v[112:127]
  ds_read_b64_tr_b16 v[44:45], v17 offset:25120
  ds_read_b64_tr_b16 v[46:47], v17 offset:26528
  v_mfma_f32_32x32x16_bf16 v[128:143], v[48:51], v[32:35], v[128:143]
  ds_read_b64_tr_b16 v[48:49], v17 offset:25152
  ds_read_b64_tr_b16 v[50:51], v17 offset:26560
  v_mfma_f32_32x32x16_bf16 v[144:159], v[52:55], v[32:35], v[144:159]
  ds_read_b64_tr_b16 v[52:53], v17 offset:25184
  ds_read_b64_tr_b16 v[54:55], v17 offset:26592
  s_add_u32 m0, s78, 121472
  s_nop 0
  buffer_load_dwordx4 v4, s[32:35], s88 offen lds
  v_mfma_f32_32x32x16_bf16 v[160:175], v[56:59], v[32:35], v[160:175]
  ds_read_b64_tr_b16 v[56:57], v17 offset:25216
  ds_read_b64_tr_b16 v[58:59], v17 offset:26624
  s_cbranch_vccnz L_u6_50
  v_mfma_f32_32x32x16_bf16 v[176:191], v[60:63], v[32:35], v[176:191]
  ds_read_b64_tr_b16 v[60:61], v17 offset:25248
  ds_read_b64_tr_b16 v[62:63], v17 offset:26656
L_u6_50:
  ds_read_b128 v[32:35], v10 offset:16384
  s_waitcnt lgkmcnt(11)
  v_mfma_f32_32x32x16_bf16 v[96:111], v[64:67], v[36:39], v[96:111]
  ds_read_b64_tr_b16 v[64:65], v17 offset:30720
  ds_read_b64_tr_b16 v[66:67], v17 offset:32128
  s_bfe_u32 s89, s63, 262168
  s_mul_i32 s89, s89, 176128
  s_add_u32 s89, s89, s64
  s_add_u32 m0, s75, 45312
  s_nop 0
  buffer_load_dwordx4 v5, s[36:39], s89 offen lds
  v_mfma_f32_32x32x16_bf16 v[112:127], v[68:71], v[36:39], v[112:127]
  ds_read_b64_tr_b16 v[68:69], v17 offset:30752
  ds_read_b64_tr_b16 v[70:71], v17 offset:32160
  v_mfma_f32_32x32x16_bf16 v[128:143], v[72:75], v[36:39], v[128:143]
  ds_read_b64_tr_b16 v[72:73], v17 offset:30784
  ds_read_b64_tr_b16 v[74:75], v17 offset:32192
  v_mfma_f32_32x32x16_bf16 v[144:159], v[76:79], v[36:39], v[144:159]
  ds_read_b64_tr_b16 v[76:77], v17 offset:30816
  ds_read_b64_tr_b16 v[78:79], v17 offset:32224
  s_add_u32 m0, s76, 45312
  s_nop 0
  buffer_load_dwordx4 v6, s[40:43], s89 offen lds
  v_mfma_f32_32x32x16_bf16 v[160:175], v[80:83], v[36:39], v[160:175]
  ds_read_b64_tr_b16 v[80:81], v17 offset:30848
  ds_read_b64_tr_b16 v[82:83], v17 offset:32256
  s_cbranch_vccnz L_u6_51
  v_mfma_f32_32x32x16_bf16 v[176:191], v[84:87], v[36:39], v[176:191]
  ds_read_b64_tr_b16 v[84:85], v17 offset:30880
  ds_read_b64_tr_b16 v[86:87], v17 offset:32288
L_u6_51:
  ds_read_b128 v[36:39], v11 offset:16384
  s_waitcnt vmcnt(7) lgkmcnt(11)
  s_barrier
  v_mfma_f32_32x32x16_bf16 v[96:111], v[40:43], v[32:35], v[96:111]
  ds_read_b64_tr_b16 v[40:41], v16 offset:0
  ds_read_b64_tr_b16 v[42:43], v16 offset:1408
  s_and_b32 s74, s79, 45312
  s_add_u32 m0, s74, s77
  s_nop 0
  buffer_load_dwordx4 v7, s[44:47], s89 offen lds
  v_mfma_f32_32x32x16_bf16 v[112:127], v[44:47], v[32:35], v[112:127]
  ds_read_b64_tr_b16 v[44:45], v16 offset:32
  ds_read_b64_tr_b16 v[46:47], v16 offset:1440
  v_mfma_f32_32x32x16_bf16 v[128:143], v[48:51], v[32:35], v[128:143]
  ds_read_b64_tr_b16 v[48:49], v16 offset:64
  ds_read_b64_tr_b16 v[50:51], v16 offset:1472
  v_mfma_f32_32x32x16_bf16 v[144:159], v[52:55], v[32:35], v[144:159]
  ds_read_b64_tr_b16 v[52:53], v16 offset:96
  ds_read_b64_tr_b16 v[54:55], v16 offset:1504
  s_bfe_u32 s90, s63, 262168
  s_mul_i32 s90, s90, 176128
  s_add_u32 s90, s90, s65
  s_add_u32 m0, s75, 67968
  s_nop 0
  buffer_load_dwordx4 v5, s[36:39], s90 offen lds
  v_mfma_f32_32x32x16_bf16 v[160:175], v[56:59], v[32:35], v[160:175]
  ds_read_b64_tr_b16 v[56:57], v16 offset:128
  ds_read_b64_tr_b16 v[58:59], v16 offset:1536
  s_cbranch_vccnz L_u6_52
  v_mfma_f32_32x32x16_bf16 v[176:191], v[60:63], v[32:35], v[176:191]
  ds_read_b64_tr_b16 v[60:61], v16 offset:160
  ds_read_b64_tr_b16 v[62:63], v16 offset:1568
L_u6_52:
  ds_read_b128 v[32:35], v8 offset:32768
  s_waitcnt lgkmcnt(11)
  v_mfma_f32_32x32x16_bf16 v[96:111], v[64:67], v[36:39], v[96:111]
  ds_read_b64_tr_b16 v[64:65], v16 offset:5632
  ds_read_b64_tr_b16 v[66:67], v16 offset:7040
  s_add_u32 m0, s76, 67968
  s_nop 0
  buffer_load_dwordx4 v6, s[40:43], s90 offen lds
  v_mfma_f32_32x32x16_bf16 v[112:127], v[68:71], v[36:39], v[112:127]
  ds_read_b64_tr_b16 v[68:69], v16 offset:5664
  ds_read_b64_tr_b16 v[70:71], v16 offset:7072
  v_mfma_f32_32x32x16_bf16 v[128:143], v[72:75], v[36:39], v[128:143]
  ds_read_b64_tr_b16 v[72:73], v16 offset:5696
  ds_read_b64_tr_b16 v[74:75], v16 offset:7104
  v_mfma_f32_32x32x16_bf16 v[144:159], v[76:79], v[36:39], v[144:159]
  ds_read_b64_tr_b16 v[76:77], v16 offset:5728
  ds_read_b64_tr_b16 v[78:79], v16 offset:7136
  s_and_b32 s74, s79, 67968
  s_add_u32 m0, s74, s77
  s_nop 0
  buffer_load_dwordx4 v7, s[44:47], s90 offen lds
  v_mfma_f32_32x32x16_bf16 v[160:175], v[80:83], v[36:39], v[160:175]
  ds_read_b64_tr_b16 v[80:81], v16 offset:5760
  ds_read_b64_tr_b16 v[82:83], v16 offset:7168
  s_cbranch_vccnz L_u6_53
  v_mfma_f32_32x32x16_bf16 v[176:191], v[84:87], v[36:39], v[176:191]
  ds_read_b64_tr_b16 v[84:85], v16 offset:5792
  ds_read_b64_tr_b16 v[86:87], v16 offset:7200
L_u6_53:
  ds_read_b128 v[36:39], v9 offset:32768
  s_waitcnt vmcnt(8) lgkmcnt(11)
  s_barrier
  v_mfma_f32_32x32x16_bf16 v[96:111], v[40:43], v[32:35], v[96:111]
  ds_read_b64_tr_b16 v[40:41], v16 offset:22656
  ds_read_b64_tr_b16 v[42:43], v16 offset:24064
  buffer_load_dword v25, v249, s[48:51], 0 offen sc1
  buffer_load_dword v20, v250, s[48:51], 0 offen sc1
  v_mfma_f32_32x32x16_bf16 v[112:127], v[44:47], v[32:35], v[112:127]
  ds_read_b64_tr_b16 v[44:45], v16 offset:22688
  ds_read_b64_tr_b16 v[46:47], v16 offset:24096
  v_mfma_f32_32x32x16_bf16 v[128:143], v[48:51], v[32:35], v[128:143]
  ds_read_b64_tr_b16 v[48:49], v16 offset:22720
  ds_read_b64_tr_b16 v[50:51], v16 offset:24128
  s_bfe_u32 s88, s63, 262172
  s_lshl_b32 s88, s88, 7
  s_add_u32 s88, s88, s66
  s_add_u32 m0, s78, 129664
  s_nop 0
  buffer_load_dwordx4 v3, s[32:35], s88 offen lds
  v_mfma_f32_32x32x16_bf16 v[144:159], v[52:55], v[32:35], v[144:159]
  ds_read_b64_tr_b16 v[52:53], v16 offset:22752
  ds_read_b64_tr_b16 v[54:55], v16 offset:24160
  v_mfma_f32_32x32x16_bf16 v[160:175], v[56:59], v[32:35], v[160:175]
  ds_read_b64_tr_b16 v[56:57], v16 offset:22784
  ds_read_b64_tr_b16 v[58:59], v16 offset:24192
  s_add_u32 m0, s78, 137856
  s_nop 0
  buffer_load_dwordx4 v4, s[32:35], s88 offen lds
  s_cbranch_vccnz L_u6_54
  v_mfma_f32_32x32x16_bf16 v[176:191], v[60:63], v[32:35], v[176:191]
  ds_read_b64_tr_b16 v[60:61], v16 offset:22816
  ds_read_b64_tr_b16 v[62:63], v16 offset:24224
L_u6_54:
  ds_read_b128 v[32:35], v10 offset:32768
  s_waitcnt lgkmcnt(11)
  v_mfma_f32_32x32x16_bf16 v[96:111], v[64:67], v[36:39], v[96:111]
  ds_read_b64_tr_b16 v[64:65], v16 offset:28288
  ds_read_b64_tr_b16 v[66:67], v16 offset:29696
  s_bfe_u32 s89, s63, 262172
  s_mul_i32 s89, s89, 176128
  s_add_u32 s89, s89, s64
  s_add_u32 m0, s75, 90624
  s_nop 0
  buffer_load_dwordx4 v5, s[36:39], s89 offen lds
  v_mfma_f32_32x32x16_bf16 v[112:127], v[68:71], v[36:39], v[112:127]
  ds_read_b64_tr_b16 v[68:69], v16 offset:28320
  ds_read_b64_tr_b16 v[70:71], v16 offset:29728
  v_mfma_f32_32x32x16_bf16 v[128:143], v[72:75], v[36:39], v[128:143]
  ds_read_b64_tr_b16 v[72:73], v16 offset:28352
  ds_read_b64_tr_b16 v[74:75], v16 offset:29760
  v_mfma_f32_32x32x16_bf16 v[144:159], v[76:79], v[36:39], v[144:159]
  ds_read_b64_tr_b16 v[76:77], v16 offset:28384
  ds_read_b64_tr_b16 v[78:79], v16 offset:29792
  s_add_u32 m0, s76, 90624
  s_nop 0
  buffer_load_dwordx4 v6, s[40:43], s89 offen lds
  v_mfma_f32_32x32x16_bf16 v[160:175], v[80:83], v[36:39], v[160:175]
  ds_read_b64_tr_b16 v[80:81], v16 offset:28416
  ds_read_b64_tr_b16 v[82:83], v16 offset:29824
  s_cbranch_vccnz L_u6_55
  v_mfma_f32_32x32x16_bf16 v[176:191], v[84:87], v[36:39], v[176:191]
  ds_read_b64_tr_b16 v[84:85], v16 offset:28448
  ds_read_b64_tr_b16 v[86:87], v16 offset:29856
L_u6_55:
  ds_read_b128 v[36:39], v11 offset:32768
  s_waitcnt vmcnt(9) lgkmcnt(11)
  s_barrier
  v_mfma_f32_32x32x16_bf16 v[96:111], v[40:43], v[32:35], v[96:111]
  ds_read_b64_tr_b16 v[40:41], v16 offset:45312
  ds_read_b64_tr_b16 v[42:43], v16 offset:46720
  s_and_b32 s74, s79, 90624
  s_add_u32 m0, s74, s77
  s_nop 0
  buffer_load_dwordx4 v7, s[44:47], s89 offen lds
  v_mfma_f32_32x32x16_bf16 v[112:127], v[44:47], v[32:35], v[112:127]
  ds_read_b64_tr_b16 v[44:45], v16 offset:45344
  ds_read_b64_tr_b16 v[46:47], v16 offset:46752
  v_mfma_f32_32x32x16_bf16 v[128:143], v[48:51], v[32:35], v[128:143]
  ds_read_b64_tr_b16 v[48:49], v16 offset:45376
  ds_read_b64_tr_b16 v[50:51], v16 offset:46784
  v_mfma_f32_32x32x16_bf16 v[144:159], v[52:55], v[32:35], v[144:159]
  ds_read_b64_tr_b16 v[52:53], v16 offset:45408
  ds_read_b64_tr_b16 v[54:55], v16 offset:46816
  s_bfe_u32 s90, s63, 262172
  s_mul_i32 s90, s90, 176128
  s_add_u32 s90, s90, s65
  s_add_u32 m0, s75, 0
  s_nop 0
  buffer_load_dwordx4 v5, s[36:39], s90 offen lds
  v_mfma_f32_32x32x16_bf16 v[160:175], v[56:59], v[32:35], v[160:175]
  ds_read_b64_tr_b16 v[56:57], v16 offset:45440
  ds_read_b64_tr_b16 v[58:59], v16 offset:46848
  s_cbranch_vccnz L_u6_56
  v_mfma_f32_32x32x16_bf16 v[176:191], v[60:63], v[32:35], v[176:191]
  ds_read_b64_tr_b16 v[60:61], v16 offset:45472
  ds_read_b64_tr_b16 v[62:63], v16 offset:46880
L_u6_56:
  ds_read_b128 v[32:35], v8 offset:0
  s_waitcnt lgkmcnt(11)
  v_mfma_f32_32x32x16_bf16 v[96:111], v[64:67], v[36:39], v[96:111]
  ds_read_b64_tr_b16 v[64:65], v16 offset:50944
  ds_read_b64_tr_b16 v[66:67], v16 offset:52352
  s_add_u32 m0, s76, 0
  s_nop 0
  buffer_load_dwordx4 v6, s[40:43], s90 offen lds
  v_mfma_f32_32x32x16_bf16 v[112:127], v[68:71], v[36:39], v[112:127]
  ds_read_b64_tr_b16 v[68:69], v16 offset:50976
  ds_read_b64_tr_b16 v[70:71], v16 offset:52384
  v_mfma_f32_32x32x16_bf16 v[128:143], v[72:75], v[36:39], v[128:143]
  ds_read_b64_tr_b16 v[72:73], v16 offset:51008
  ds_read_b64_tr_b16 v[74:75], v16 offset:52416
  v_mfma_f32_32x32x16_bf16 v[144:159], v[76:79], v[36:39], v[144:159]
  ds_read_b64_tr_b16 v[76:77], v16 offset:51040
  ds_read_b64_tr_b16 v[78:79], v16 offset:52448
  s_and_b32 s74, s79, 0
  s_add_u32 m0, s74, s77
  s_nop 0
  buffer_load_dwordx4 v7, s[44:47], s90 offen lds
  v_mfma_f32_32x32x16_bf16 v[160:175], v[80:83], v[36:39], v[160:175]
  ds_read_b64_tr_b16 v[80:81], v16 offset:51072
  ds_read_b64_tr_b16 v[82:83], v16 offset:52480
  s_cbranch_vccnz L_u6_57
  v_mfma_f32_32x32x16_bf16 v[176:191], v[84:87], v[36:39], v[176:191]
  ds_read_b64_tr_b16 v[84:85], v16 offset:51104
  ds_read_b64_tr_b16 v[86:87], v16 offset:52512
L_u6_57:
  ds_read_b128 v[36:39], v9 offset:0
  s_waitcnt vmcnt(10) lgkmcnt(11)
  s_barrier
  v_mfma_f32_32x32x16_bf16 v[96:111], v[40:43], v[32:35], v[96:111]
  ds_read_b64_tr_b16 v[40:41], v17 offset:2432
  ds_read_b64_tr_b16 v[42:43], v17 offset:3840
  s_waitcnt vmcnt(8)
  v_readfirstlane_b32 s69, v25
  s_nop 1
  s_cmp_lt_u32 s69, 16
  s_cbranch_scc1 L_slow_cs_f
L_back_cs_f:
  v_readfirstlane_b32 s69, v20
  s_nop 1
  s_cmp_lt_u32 s69, 8
  s_cbranch_scc1 L_slow_st_f
L_back_st_f:
  v_mfma_f32_32x32x16_bf16 v[112:127], v[44:47], v[32:35], v[112:127]
  ds_read_b64_tr_b16 v[44:45], v17 offset:2464
  ds_read_b64_tr_b16 v[46:47], v17 offset:3872
  buffer_load_dword v240, v251, s[48:51], 0 offen offset:0 sc1
  buffer_load_dword v241, v251, s[48:51], 0 offen offset:128 sc1
  buffer_load_dword v242, v251, s[48:51], 0 offen offset:256 sc1
  buffer_load_dword v243, v251, s[48:51], 0 offen offset:384 sc1
  buffer_load_dword v244, v251, s[48:51], 0 offen offset:512 sc1
  buffer_load_dword v245, v251, s[48:51], 0 offen offset:640 sc1
  buffer_load_dword v252, v248, s[48:51], 0 offen sc1
  s_mov_b32 s70, 8192
  buffer_load_dword v253, v248, s[48:51], s70 offen sc1
  v_mfma_f32_32x32x16_bf16 v[128:143], v[48:51], v[32:35], v[128:143]
  ds_read_b64_tr_b16 v[48:49], v17 offset:2496
  ds_read_b64_tr_b16 v[50:51], v17 offset:3904
  s_mov_b32 s32, s22
  s_and_b32 s33, s23, 0xffff
  s_mov_b32 s34, 1409024
  s_lshl_b32 s88, s87, 14
  v_mfma_f32_32x32x16_bf16 v[144:159], v[52:55], v[32:35], v[144:159]
  ds_read_b64_tr_b16 v[52:53], v17 offset:2528
  ds_read_b64_tr_b16 v[54:55], v17 offset:3936
  s_add_u32 s73, s3, 0
  s_cmp_ge_u32 s73, s4
  s_cselect_b32 s71, s4, 0
  s_sub_u32 s73, s73, s71
  s_lshl_b32 s73, s73, 14
  s_add_u32 s73, s73, s88
  s_add_u32 m0, s98, 146048
  s_nop 0
  buffer_load_dwordx4 v27, s[32:35], s73 offen lds
  v_mfma_f32_32x32x16_bf16 v[160:175], v[56:59], v[32:35], v[160:175]
  ds_read_b64_tr_b16 v[56:57], v17 offset:2560
  ds_read_b64_tr_b16 v[58:59], v17 offset:3968
  s_add_u32 s73, s3, 1
  s_cmp_ge_u32 s73, s4
  s_cselect_b32 s71, s4, 0
  s_sub_u32 s73, s73, s71
  s_lshl_b32 s73, s73, 14
  s_add_u32 s73, s73, s88
  s_add_u32 m0, s98, 154240
  s_nop 0
  buffer_load_dwordx4 v27, s[32:35], s73 offen lds
  s_cbranch_vccnz L_u6_58
  v_mfma_f32_32x32x16_bf16 v[176:191], v[60:63], v[32:35], v[176:191]
  ds_read_b64_tr_b16 v[60:61], v17 offset:2592
  ds_read_b64_tr_b16 v[62:63], v17 offset:4000
L_u6_58:
  ds_read_b128 v[32:35], v10 offset:0
  s_waitcnt lgkmcnt(11)
  v_mfma_f32_32x32x16_bf16 v[96:111], v[64:67], v[36:39], v[96:111]
  ds_read_b64_tr_b16 v[64:65], v17 offset:8064
  ds_read_b64_tr_b16 v[66:67], v17 offset:9472
  s_add_u32 s73, s3, 2
  s_cmp_ge_u32 s73, s4
  s_cselect_b32 s71, s4, 0
  s_sub_u32 s73, s73, s71
  s_lshl_b32 s73, s73, 14
  s_add_u32 s73, s73, s88
  s_add_u32 m0, s98, 22656
  s_nop 0
  buffer_load_dwordx4 v27, s[32:35], s73 offen lds
  v_mfma_f32_32x32x16_bf16 v[112:127], v[68:71], v[36:39], v[112:127]
  ds_read_b64_tr_b16 v[68:69], v17 offset:8096
  ds_read_b64_tr_b16 v[70:71], v17 offset:9504
  v_mfma_f32_32x32x16_bf16 v[128:143], v[72:75], v[36:39], v[128:143]
  ds_read_b64_tr_b16 v[72:73], v17 offset:8128
  ds_read_b64_tr_b16 v[74:75], v17 offset:9536
  v_mfma_f32_32x32x16_bf16 v[144:159], v[76:79], v[36:39], v[144:159]
  ds_read_b64_tr_b16 v[76:77], v17 offset:8160
  ds_read_b64_tr_b16 v[78:79], v17 offset:9568
  s_add_u32 s73, s3, 3
  s_cmp_ge_u32 s73, s4
  s_cselect_b32 s71, s4, 0
  s_sub_u32 s73, s73, s71
  s_lshl_b32 s73, s73, 14
  s_add_u32 s73, s73, s88
  s_add_u32 m0, s98, 30848
  s_nop 0
  buffer_load_dwordx4 v27, s[32:35], s73 offen lds
  v_mfma_f32_32x32x16_bf16 v[160:175], v[80:83], v[36:39], v[160:175]
  ds_read_b64_tr_b16 v[80:81], v17 offset:8192
  ds_read_b64_tr_b16 v[82:83], v17 offset:9600
  s_cbranch_vccnz L_u6_59
  v_mfma_f32_32x32x16_bf16 v[176:191], v[84:87], v[36:39], v[176:191]
  ds_read_b64_tr_b16 v[84:85], v17 offset:8224
  ds_read_b64_tr_b16 v[86:87], v17 offset:9632
L_u6_59:
  ds_read_b128 v[36:39], v11 offset:0
  s_waitcnt vmcnt(15) lgkmcnt(11)
  s_barrier
  v_mfma_f32_32x32x16_bf16 v[96:111], v[40:43], v[32:35], v[96:111]
  ds_read_b64_tr_b16 v[40:41], v17 offset:25088
  ds_read_b64_tr_b16 v[42:43], v17 offset:26496
  s_add_u32 s73, s3, 4
  s_cmp_ge_u32 s73, s4
  s_cselect_b32 s71, s4, 0
  s_sub_u32 s73, s73, s71
  s_lshl_b32 s73, s73, 14
  s_add_u32 s73, s73, s88
  s_add_u32 m0, s98, 45312
  s_nop 0
  buffer_load_dwordx4 v27, s[32:35], s73 offen lds
  v_mfma_f32_32x32x16_bf16 v[112:127], v[44:47], v[32:35], v[112:127]
  ds_read_b64_tr_b16 v[44:45], v17 offset:25120
  ds_read_b64_tr_b16 v[46:47], v17 offset:26528
  v_mfma_f32_32x32x16_bf16 v[128:143], v[48:51], v[32:35], v[128:143]
  ds_read_b64_tr_b16 v[48:49], v17 offset:25152
  ds_read_b64_tr_b16 v[50:51], v17 offset:26560
  v_mfma_f32_32x32x16_bf16 v[144:159], v[52:55], v[32:35], v[144:159]
  ds_read_b64_tr_b16 v[52:53], v17 offset:25184
  ds_read_b64_tr_b16 v[54:55], v17 offset:26592
  v_mfma_f32_32x32x16_bf16 v[160:175], v[56:59], v[32:35], v[160:175]
  ds_read_b64_tr_b16 v[56:57], v17 offset:25216
  ds_read_b64_tr_b16 v[58:59], v17 offset:26624
  s_cbranch_vccnz L_u6_60
  v_mfma_f32_32x32x16_bf16 v[176:191], v[60:63], v[32:35], v[176:191]
  ds_read_b64_tr_b16 v[60:61], v17 offset:25248
  ds_read_b64_tr_b16 v[62:63], v17 offset:26656
L_u6_60:
  ds_read_b128 v[32:35], v8 offset:16384
  s_waitcnt lgkmcnt(11)
  v_mfma_f32_32x32x16_bf16 v[96:111], v[64:67], v[36:39], v[96:111]
  ds_read_b64_tr_b16 v[64:65], v17 offset:30720
  ds_read_b64_tr_b16 v[66:67], v17 offset:32128
  s_add_u32 s73, s3, 5
  s_cmp_ge_u32 s73, s4
  s_cselect_b32 s71, s4, 0
  s_sub_u32 s73, s73, s71
  s_lshl_b32 s73, s73, 14
  s_add_u32 s73, s73, s88
  s_add_u32 m0, s98, 53504
  s_nop 0
  buffer_load_dwordx4 v27, s[32:35], s73 offen lds
  v_mfma_f32_32x32x16_bf16 v[112:127], v[68:71], v[36:39], v[112:127]
  ds_read_b64_tr_b16 v[68:69], v17 offset:30752
  ds_read_b64_tr_b16 v[70:71], v17 offset:32160
  v_mfma_f32_32x32x16_bf16 v[128:143], v[72:75], v[36:39], v[128:143]
  ds_read_b64_tr_b16 v[72:73], v17 offset:30784
  ds_read_b64_tr_b16 v[74:75], v17 offset:32192
  v_mfma_f32_32x32x16_bf16 v[144:159], v[76:79], v[36:39], v[144:159]
  ds_read_b64_tr_b16 v[76:77], v17 offset:30816
  ds_read_b64_tr_b16 v[78:79], v17 offset:32224
  v_mfma_f32_32x32x16_bf16 v[160:175], v[80:83], v[36:39], v[160:175]
  ds_read_b64_tr_b16 v[80:81], v17 offset:30848
  ds_read_b64_tr_b16 v[82:83], v17 offset:32256
  s_cbranch_vccnz L_u6_61
  v_mfma_f32_32x32x16_bf16 v[176:191], v[84:87], v[36:39], v[176:191]
  ds_read_b64_tr_b16 v[84:85], v17 offset:30880
  ds_read_b64_tr_b16 v[86:87], v17 offset:32288
L_u6_61:
  ds_read_b128 v[36:39], v9 offset:16384
  s_waitcnt vmcnt(6)
  s_barrier
  ds_read_b128 v[208:211], v10 offset:16384
  ds_read_b128 v[212:215], v11 offset:16384
  ds_read_b64_tr_b16 v[216:217], v16 offset:0
  ds_read_b64_tr_b16 v[218:219], v16 offset:1408
  ds_read_b64_tr_b16 v[220:221], v16 offset:5632
  ds_read_b64_tr_b16 v[222:223], v16 offset:7040
  ds_read_b64_tr_b16 v[224:225], v16 offset:32
  ds_read_b64_tr_b16 v[226:227], v16 offset:1440
  ds_read_b64_tr_b16 v[228:229], v16 offset:5664
  ds_read_b64_tr_b16 v[230:231], v16 offset:7072
  s_waitcnt lgkmcnt(10)
  v_mfma_f32_32x32x16_bf16 v[96:111], v[40:43], v[32:35], v[96:111]
  v_cmp_gt_u32 s[30:31], 32, v1
  v_mov_b32 v202, 0
  v_mov_b32 v203, 0
  v_mov_b32 v206, 0
  v_mov_b32 v207, 0
  v_cndmask_b32 v23, 0, -1, s[30:31]
  v_mov_b32 v94, 0
  v_mov_b32 v95, 0
  v_mul_f32 v196, 0x3b000000, v252
  v_mul_f32 v198, 0x3b000000, v253
  v_fma_f32 v198, -v196, v196, v198
  v_max_f32 v198, 0, v198
  v_add_f32 v198, 0x3727c5ac, v198
  v_rsq_f32 v26, v198
  v_sub_f32 v196, 0, v196
  s_add_u32 s73, s3, 6
  s_cmp_ge_u32 s73, s4
  s_cselect_b32 s71, s4, 0
  s_sub_u32 s73, s73, s71
  s_lshl_b32 s73, s73, 14
  s_add_u32 s73, s73, s88
  s_add_u32 m0, s98, 113280
  s_nop 0
  buffer_load_dwordx4 v27, s[32:35], s73 offen lds
  v_mfma_f32_32x32x16_bf16 v[96:111], v[64:67], v[36:39], v[96:111]
  v_cvt_pk_bf16_f32 v92, v196, v196
  v_and_b32 v197, 0xffff0000, v92
  v_sub_f32 v197, v196, v197
  v_cvt_pk_bf16_f32 v93, v197, v2
  v_mul_f32 v28, v26, v26
  s_lshl_b32 s69, s57, 2
  s_add_u32 s69, s69, s55
  s_mul_i32 s69, s69, 86
  s_add_u32 s69, s69, s80
  s_mul_i32 s70, s56, 6
  s_add_u32 s69, s69, s70
  s_lshl_b32 s69, s69, 10
  s_add_u32 s64, s69, 0
  v_lshlrev_b32 v21, 4, v1
  s_add_u32 s73, s3, 7
  s_cmp_ge_u32 s73, s4
  s_cselect_b32 s71, s4, 0
  s_sub_u32 s73, s73, s71
  s_lshl_b32 s73, s73, 14
  s_add_u32 s73, s73, s88
  s_add_u32 m0, s98, 121472
  s_nop 0
  buffer_load_dwordx4 v27, s[32:35], s73 offen lds
  s_waitcnt lgkmcnt(4)
  v_mfma_f32_32x32x16_bf16 v[96:111], v[216:219], v[208:211], v[96:111]
  v_cvt_pk_bf16_f32 v200, v240, v240
  v_lshlrev_b32 v201, 16, v200
  v_sub_f32 v201, v240, v201
  v_cvt_pk_bf16_f32 v200, v240, v201
  v_and_b32 v200, v23, v200
  v_and_b32 v201, 0xffff, v200
  s_add_u32 s73, s3, 8
  s_cmp_ge_u32 s73, s4
  s_cselect_b32 s71, s4, 0
  s_sub_u32 s73, s73, s71
  s_lshl_b32 s73, s73, 14
  s_add_u32 s73, s73, s88
  s_add_u32 m0, s98, 67968
  s_nop 0
  buffer_load_dwordx4 v27, s[32:35], s73 offen lds
  v_mfma_f32_32x32x16_bf16 v[96:111], v[220:223], v[212:215], v[96:111]
  ds_read_b64_tr_b16 v[216:217], v16 offset:64
  ds_read_b64_tr_b16 v[218:219], v16 offset:1472
  ds_read_b64_tr_b16 v[220:221], v16 offset:5696
  ds_read_b64_tr_b16 v[222:223], v16 offset:7104
  v_cvt_pk_bf16_f32 v204, v241, v241
  v_lshlrev_b32 v205, 16, v204
  v_sub_f32 v205, v241, v205
  v_cvt_pk_bf16_f32 v204, v241, v205
  v_and_b32 v204, v23, v204
  v_and_b32 v205, 0xffff, v204
  s_add_u32 s73, s3, 9
  s_cmp_ge_u32 s73, s4
  s_cselect_b32 s71, s4, 0
  s_sub_u32 s73, s73, s71
  s_lshl_b32 s73, s73, 14
  s_add_u32 s73, s73, s88
  s_add_u32 m0, s98, 76160
  s_nop 0
  buffer_load_dwordx4 v27, s[32:35], s73 offen lds
  v_mfma_f32_32x32x16_bf16 v[96:111], v[200:203], v[92:95], v[96:111]
  s_waitcnt lgkmcnt(4)
  v_mfma_f32_32x32x16_bf16 v[112:127], v[44:47], v[32:35], v[112:127]
  v_cvt_pk_bf16_f32 v200, v242, v242
  v_lshlrev_b32 v201, 16, v200
  v_sub_f32 v201, v242, v201
  v_cvt_pk_bf16_f32 v200, v242, v201
  v_and_b32 v200, v23, v200
  v_and_b32 v201, 0xffff, v200
  v_mfma_f32_32x32x16_bf16 v[112:127], v[68:71], v[36:39], v[112:127]
  s_nop 2
  v_max_f32 v96, 0, v96
  v_max_f32 v97, 0, v97
  v_max_f32 v98, 0, v98
  v_max_f32 v99, 0, v99
  v_max_f32 v100, 0, v100
  v_max_f32 v101, 0, v101
  v_max_f32 v102, 0, v102
  v_max_f32 v103, 0, v103
  v_mfma_f32_32x32x16_bf16 v[112:127], v[224:227], v[208:211], v[112:127]
  v_mul_f32 v104, v104, v28
  v_mul_f32 v105, v105, v28
  v_mul_f32 v106, v106, v28
  v_mul_f32 v107, v107, v28
  v_mul_f32 v108, v108, v28
  v_mul_f32 v109, v109, v28
  v_mul_f32 v110, v110, v28
  v_mul_f32 v111, v111, v28
  v_mfma_f32_32x32x16_bf16 v[112:127], v[228:231], v[212:215], v[112:127]
  ds_read_b64_tr_b16 v[224:225], v16 offset:96
  ds_read_b64_tr_b16 v[226:227], v16 offset:1504
  ds_read_b64_tr_b16 v[228:229], v16 offset:5728
  ds_read_b64_tr_b16 v[230:231], v16 offset:7136
  v_mul_f32 v96, v96, v104
  v_mul_f32 v97, v97, v105
  v_mul_f32 v98, v98, v106
  v_mul_f32 v99, v99, v107
  v_mul_f32 v100, v100, v108
  v_mul_f32 v101, v101, v109
  v_mul_f32 v102, v102, v110
  v_mul_f32 v103, v103, v111
  v_mfma_f32_32x32x16_bf16 v[112:127], v[204:207], v[92:95], v[112:127]
  v_cvt_pk_bf16_f32 v232, v96, v97
  v_cvt_pk_bf16_f32 v233, v98, v99
  v_cvt_pk_bf16_f32 v234, v100, v101
  v_cvt_pk_bf16_f32 v235, v102, v103
  s_add_u32 s72, s64, 0
  buffer_store_dwordx4 v[232:235], v21, s[48:51], s72 offen sc1
  s_waitcnt lgkmcnt(4)
  v_mfma_f32_32x32x16_bf16 v[128:143], v[48:51], v[32:35], v[128:143]
  v_cvt_pk_bf16_f32 v204, v243, v243
  v_lshlrev_b32 v205, 16, v204
  v_sub_f32 v205, v243, v205
  v_cvt_pk_bf16_f32 v204, v243, v205
  v_and_b32 v204, v23, v204
  v_and_b32 v205, 0xffff, v204
  v_mfma_f32_32x32x16_bf16 v[128:143], v[72:75], v[36:39], v[128:143]
  v_max_f32 v112, 0, v112
  v_max_f32 v113, 0, v113
  v_max_f32 v114, 0, v114
  v_max_f32 v115, 0, v115
  v_max_f32 v116, 0, v116
  v_max_f32 v117, 0, v117
  v_max_f32 v118, 0, v118
  v_max_f32 v119, 0, v119
  v_mfma_f32_32x32x16_bf16 v[128:143], v[216:219], v[208:211], v[128:143]
  v_mul_f32 v120, v120, v28
  v_mul_f32 v121, v121, v28
  v_mul_f32 v122, v122, v28
  v_mul_f32 v123, v123, v28
  v_mul_f32 v124, v124, v28
  v_mul_f32 v125, v125, v28
  v_mul_f32 v126, v126, v28
  v_mul_f32 v127, v127, v28
  v_mfma_f32_32x32x16_bf16 v[128:143], v[220:223], v[212:215], v[128:143]
  ds_read_b64_tr_b16 v[216:217], v16 offset:128
  ds_read_b64_tr_b16 v[218:219], v16 offset:1536
  ds_read_b64_tr_b16 v[220:221], v16 offset:5760
  ds_read_b64_tr_b16 v[222:223], v16 offset:7168
  v_mul_f32 v112, v112, v120
  v_mul_f32 v113, v113, v121
  v_mul_f32 v114, v114, v122
  v_mul_f32 v115, v115, v123
  v_mul_f32 v116, v116, v124
  v_mul_f32 v117, v117, v125
  v_mul_f32 v118, v118, v126
  v_mul_f32 v119, v119, v127
  v_mfma_f32_32x32x16_bf16 v[128:143], v[200:203], v[92:95], v[128:143]
  v_cvt_pk_bf16_f32 v236, v112, v113
  v_cvt_pk_bf16_f32 v237, v114, v115
  v_cvt_pk_bf16_f32 v238, v116, v117
  v_cvt_pk_bf16_f32 v239, v118, v119
  s_add_u32 s72, s64, 1024
  buffer_store_dwordx4 v[236:239], v21, s[48:51], s72 offen sc1
  s_waitcnt lgkmcnt(4)
  v_mfma_f32_32x32x16_bf16 v[144:159], v[52:55], v[32:35], v[144:159]
  v_cvt_pk_bf16_f32 v200, v244, v244
  v_lshlrev_b32 v201, 16, v200
  v_sub_f32 v201, v244, v201
  v_cvt_pk_bf16_f32 v200, v244, v201
  v_and_b32 v200, v23, v200
  v_and_b32 v201, 0xffff, v200
  v_mfma_f32_32x32x16_bf16 v[144:159], v[76:79], v[36:39], v[144:159]
  v_max_f32 v128, 0, v128
  v_max_f32 v129, 0, v129
  v_max_f32 v130, 0, v130
  v_max_f32 v131, 0, v131
  v_max_f32 v132, 0, v132
  v_max_f32 v133, 0, v133
  v_max_f32 v134, 0, v134
  v_max_f32 v135, 0, v135
  v_mfma_f32_32x32x16_bf16 v[144:159], v[224:227], v[208:211], v[144:159]
  v_mul_f32 v136, v136, v28
  v_mul_f32 v137, v137, v28
  v_mul_f32 v138, v138, v28
  v_mul_f32 v139, v139, v28
  v_mul_f32 v140, v140, v28
  v_mul_f32 v141, v141, v28
  v_mul_f32 v142, v142, v28
  v_mul_f32 v143, v143, v28
  v_mfma_f32_32x32x16_bf16 v[144:159], v[228:231], v[212:215], v[144:159]
  ds_read_b64_tr_b16 v[224:225], v16 offset:160
  ds_read_b64_tr_b16 v[226:227], v16 offset:1568
  ds_read_b64_tr_b16 v[228:229], v16 offset:5792
  ds_read_b64_tr_b16 v[230:231], v16 offset:7200
  v_mul_f32 v128, v128, v136
  v_mul_f32 v129, v129, v137
  v_mul_f32 v130, v130, v138
  v_mul_f32 v131, v131, v139
  v_mul_f32 v132, v132, v140
  v_mul_f32 v133, v133, v141
  v_mul_f32 v134, v134, v142
  v_mul_f32 v135, v135, v143
  v_mfma_f32_32x32x16_bf16 v[144:159], v[204:207], v[92:95], v[144:159]
  v_cvt_pk_bf16_f32 v232, v128, v129
  v_cvt_pk_bf16_f32 v233, v130, v131
  v_cvt_pk_bf16_f32 v234, v132, v133
  v_cvt_pk_bf16_f32 v235, v134, v135
  s_add_u32 s72, s64, 2048
  buffer_store_dwordx4 v[232:235], v21, s[48:51], s72 offen sc1
  s_waitcnt lgkmcnt(4)
  v_mfma_f32_32x32x16_bf16 v[160:175], v[56:59], v[32:35], v[160:175]
  v_cvt_pk_bf16_f32 v204, v245, v245
  v_lshlrev_b32 v205, 16, v204
  v_sub_f32 v205, v245, v205
  v_cvt_pk_bf16_f32 v204, v245, v205
  v_and_b32 v204, v23, v204
  v_and_b32 v205, 0xffff, v204
  v_mfma_f32_32x32x16_bf16 v[160:175], v[80:83], v[36:39], v[160:175]
  v_max_f32 v144, 0, v144
  v_max_f32 v145, 0, v145
  v_max_f32 v146, 0, v146
  v_max_f32 v147, 0, v147
  v_max_f32 v148, 0, v148
  v_max_f32 v149, 0, v149
  v_max_f32 v150, 0, v150
  v_max_f32 v151, 0, v151
  v_mfma_f32_32x32x16_bf16 v[160:175], v[216:219], v[208:211], v[160:175]
  v_mul_f32 v152, v152, v28
  v_mul_f32 v153, v153, v28
  v_mul_f32 v154, v154, v28
  v_mul_f32 v155, v155, v28
  v_mul_f32 v156, v156, v28
  v_mul_f32 v157, v157, v28
  v_mul_f32 v158, v158, v28
  v_mul_f32 v159, v159, v28
  v_mfma_f32_32x32x16_bf16 v[160:175], v[220:223], v[212:215], v[160:175]
  v_mul_f32 v144, v144, v152
  v_mul_f32 v145, v145, v153
  v_mul_f32 v146, v146, v154
  v_mul_f32 v147, v147, v155
  v_mul_f32 v148, v148, v156
  v_mul_f32 v149, v149, v157
  v_mul_f32 v150, v150, v158
  v_mul_f32 v151, v151, v159
  v_mfma_f32_32x32x16_bf16 v[160:175], v[200:203], v[92:95], v[160:175]
  v_cvt_pk_bf16_f32 v236, v144, v145
  v_cvt_pk_bf16_f32 v237, v146, v147
  v_cvt_pk_bf16_f32 v238, v148, v149
  v_cvt_pk_bf16_f32 v239, v150, v151
  s_add_u32 s72, s64, 3072
  buffer_store_dwordx4 v[236:239], v21, s[48:51], s72 offen sc1
  s_cbranch_vccnz L_ffn_u5
  s_waitcnt lgkmcnt(0)
  v_mfma_f32_32x32x16_bf16 v[176:191], v[60:63], v[32:35], v[176:191]
  v_mfma_f32_32x32x16_bf16 v[176:191], v[84:87], v[36:39], v[176:191]
  s_nop 1
  v_max_f32 v160, 0, v160
  v_max_f32 v161, 0, v161
  v_max_f32 v162, 0, v162
  v_max_f32 v163, 0, v163
  v_max_f32 v164, 0, v164
  v_max_f32 v165, 0, v165
  v_max_f32 v166, 0, v166
  v_max_f32 v167, 0, v167
  v_mfma_f32_32x32x16_bf16 v[176:191], v[224:227], v[208:211], v[176:191]
  v_mul_f32 v168, v168, v28
  v_mul_f32 v169, v169, v28
  v_mul_f32 v170, v170, v28
  v_mul_f32 v171, v171, v28
  v_mul_f32 v172, v172, v28
  v_mul_f32 v173, v173, v28
  v_mul_f32 v174, v174, v28
  v_mul_f32 v175, v175, v28
  v_mfma_f32_32x32x16_bf16 v[176:191], v[228:231], v[212:215], v[176:191]
  v_mul_f32 v160, v160, v168
  v_mul_f32 v161, v161, v169
  v_mul_f32 v162, v162, v170
  v_mul_f32 v163, v163, v171
  v_mul_f32 v164, v164, v172
  v_mul_f32 v165, v165, v173
  v_mul_f32 v166, v166, v174
  v_mul_f32 v167, v167, v175
  v_mfma_f32_32x32x16_bf16 v[176:191], v[204:207], v[92:95], v[176:191]
  v_cvt_pk_bf16_f32 v232, v160, v161
  v_cvt_pk_bf16_f32 v233, v162, v163
  v_cvt_pk_bf16_f32 v234, v164, v165
  v_cvt_pk_bf16_f32 v235, v166, v167
  s_add_u32 s72, s64, 4096
  buffer_store_dwordx4 v[232:235], v21, s[48:51], s72 offen sc1
  s_nop 5
  v_max_f32 v176, 0, v176
  v_max_f32 v177, 0, v177
  v_max_f32 v178, 0, v178
  v_max_f32 v179, 0, v179
  v_max_f32 v180, 0, v180
  v_max_f32 v181, 0, v181
  v_max_f32 v182, 0, v182
  v_max_f32 v183, 0, v183
  v_mul_f32 v184, v184, v28
  v_mul_f32 v185, v185, v28
  v_mul_f32 v186, v186, v28
  v_mul_f32 v187, v187, v28
  v_mul_f32 v188, v188, v28
  v_mul_f32 v189, v189, v28
  v_mul_f32 v190, v190, v28
  v_mul_f32 v191, v191, v28
  v_mul_f32 v176, v176, v184
  v_mul_f32 v177, v177, v185
  v_mul_f32 v178, v178, v186
  v_mul_f32 v179, v179, v187
  v_mul_f32 v180, v180, v188
  v_mul_f32 v181, v181, v189
  v_mul_f32 v182, v182, v190
  v_mul_f32 v183, v183, v191
  v_cvt_pk_bf16_f32 v236, v176, v177
  v_cvt_pk_bf16_f32 v237, v178, v179
  v_cvt_pk_bf16_f32 v238, v180, v181
  v_cvt_pk_bf16_f32 v239, v182, v183
  s_add_u32 s72, s64, 5120
  buffer_store_dwordx4 v[236:239], v21, s[48:51], s72 offen sc1
  s_branch L_ffn_st5
L_ffn_u5:
  s_nop 4
  v_max_f32 v160, 0, v160
  v_max_f32 v161, 0, v161
  v_max_f32 v162, 0, v162
  v_max_f32 v163, 0, v163
  v_max_f32 v164, 0, v164
  v_max_f32 v165, 0, v165
  v_max_f32 v166, 0, v166
  v_max_f32 v167, 0, v167
  v_mul_f32 v168, v168, v28
  v_mul_f32 v169, v169, v28
  v_mul_f32 v170, v170, v28
  v_mul_f32 v171, v171, v28
  v_mul_f32 v172, v172, v28
  v_mul_f32 v173, v173, v28
  v_mul_f32 v174, v174, v28
  v_mul_f32 v175, v175, v28
  v_mul_f32 v160, v160, v168
  v_mul_f32 v161, v161, v169
  v_mul_f32 v162, v162, v170
  v_mul_f32 v163, v163, v171
  v_mul_f32 v164, v164, v172
  v_mul_f32 v165, v165, v173
  v_mul_f32 v166, v166, v174
  v_mul_f32 v167, v167, v175
  v_cvt_pk_bf16_f32 v232, v160, v161
  v_cvt_pk_bf16_f32 v233, v162, v163
  v_cvt_pk_bf16_f32 v234, v164, v165
  v_cvt_pk_bf16_f32 v235, v166, v167
  s_add_u32 s72, s64, 4096
  buffer_store_dwordx4 v[232:235], v21, s[48:51], s72 offen sc1
L_ffn_st5:
  s_mov_b32 s32, s22
  s_and_b32 s33, s23, 0xffff
  s_mov_b32 s34, 1409024
  s_mov_b32 s35, 0x20000
  s_mov_b32 s36, s14
  s_and_b32 s37, s15, 0xffff
  s_mov_b32 s38, 524288
  s_mov_b32 s39, 0x20000
  s_lshl_b32 s89, s87, 14
  s_lshl_b32 s90, s55, 17
  s_lshl_b32 s78, s55, 11
  s_lshl_b32 s69, s56, 10
  s_add_u32 s78, s78, s69
  s_waitcnt vmcnt(5)
  s_barrier
  ds_read_b64_tr_b16 v[40:41], v18 offset:14976
  ds_read_b64_tr_b16 v[42:43], v18 offset:16000
  ds_read_b64_tr_b16 v[44:45], v19 offset:14976
  ds_read_b64_tr_b16 v[46:47], v19 offset:16000
  ds_read_b64_tr_b16 v[48:49], v18 offset:23168
  ds_read_b64_tr_b16 v[50:51], v18 offset:24192
  ds_read_b64_tr_b16 v[52:53], v19 offset:23168
  ds_read_b64_tr_b16 v[54:55], v19 offset:24192
  ds_read_b64_tr_b16 v[56:57], v12 offset:22656
  ds_read_b64_tr_b16 v[58:59], v12 offset:23680
  ds_read_b64_tr_b16 v[60:61], v13 offset:22656
  ds_read_b64_tr_b16 v[62:63], v13 offset:23680
  ds_read_b64_tr_b16 v[64:65], v12 offset:30848
  ds_read_b64_tr_b16 v[66:67], v12 offset:31872
  ds_read_b64_tr_b16 v[68:69], v13 offset:30848
  ds_read_b64_tr_b16 v[70:71], v13 offset:31872
  ds_read_b64_tr_b16 v[72:73], v12 offset:45312
  ds_read_b64_tr_b16 v[74:75], v12 offset:46336
  ds_read_b64_tr_b16 v[76:77], v13 offset:45312
  ds_read_b64_tr_b16 v[78:79], v13 offset:46336
  ds_read_b64_tr_b16 v[80:81], v12 offset:53504
  ds_read_b64_tr_b16 v[82:83], v12 offset:54528
  ds_read_b64_tr_b16 v[84:85], v13 offset:53504
  ds_read_b64_tr_b16 v[86:87], v13 offset:54528
  ds_read_b64_tr_b16 v[192:193], v14 offset:47744
  ds_read_b64_tr_b16 v[194:195], v14 offset:48768
  ds_read_b64_tr_b16 v[196:197], v15 offset:47744
  ds_read_b64_tr_b16 v[198:199], v15 offset:48768
  ds_read_b64_tr_b16 v[200:201], v14 offset:55936
  ds_read_b64_tr_b16 v[202:203], v14 offset:56960
  ds_read_b64_tr_b16 v[204:205], v15 offset:55936
  ds_read_b64_tr_b16 v[206:207], v15 offset:56960
  ds_read_b64_tr_b16 v[208:209], v14 offset:2432
  ds_read_b64_tr_b16 v[210:211], v14 offset:3456
  ds_read_b64_tr_b16 v[212:213], v15 offset:2432
  ds_read_b64_tr_b16 v[214:215], v15 offset:3456
  ds_read_b64_tr_b16 v[216:217], v14 offset:10624
  ds_read_b64_tr_b16 v[218:219], v14 offset:11648
  ds_read_b64_tr_b16 v[220:221], v15 offset:10624
  ds_read_b64_tr_b16 v[222:223], v15 offset:11648
  s_waitcnt lgkmcnt(0)
  s_barrier
  s_add_u32 s74, s3, 10
  s_cmp_ge_u32 s74, s4
  s_cselect_b32 s71, s4, 0
  s_sub_u32 s74, s74, s71
  s_lshl_b32 s74, s74, 14
  s_add_u32 s74, s74, s89
  s_add_u32 m0, s78, 0
  s_nop 0
  buffer_load_dwordx4 v27, s[32:35], s74 offen lds
  s_add_u32 s74, s3, 11
  s_cmp_ge_u32 s74, s4
  s_cselect_b32 s71, s4, 0
  s_sub_u32 s74, s74, s71
  s_lshl_b32 s74, s74, 14
  s_add_u32 s74, s74, s89
  s_add_u32 m0, s78, 8192
  s_nop 0
  buffer_load_dwordx4 v27, s[32:35], s74 offen lds
  s_add_u32 s74, s3, 12
  s_cmp_ge_u32 s74, s4
  s_cselect_b32 s71, s4, 0
  s_sub_u32 s74, s74, s71
  s_lshl_b32 s74, s74, 14
  s_add_u32 s74, s74, s89
  s_add_u32 m0, s78, 16384
  s_nop 0
  buffer_load_dwordx4 v27, s[32:35], s74 offen lds
  s_add_u32 s74, s3, 13
  s_cmp_ge_u32 s74, s4
  s_cselect_b32 s71, s4, 0
  s_sub_u32 s74, s74, s71
  s_lshl_b32 s74, s74, 14
  s_add_u32 s74, s74, s89
  s_add_u32 m0, s78, 24576
  s_nop 0
  buffer_load_dwordx4 v27, s[32:35], s74 offen lds
  s_add_u32 s74, s3, 14
  s_cmp_ge_u32 s74, s4
  s_cselect_b32 s71, s4, 0
  s_sub_u32 s74, s74, s71
  s_lshl_b32 s74, s74, 14
  s_add_u32 s74, s74, s89
  s_add_u32 m0, s78, 32768
  s_nop 0
  buffer_load_dwordx4 v27, s[32:35], s74 offen lds
  s_add_u32 s74, s3, 15
  s_cmp_ge_u32 s74, s4
  s_cselect_b32 s71, s4, 0
  s_sub_u32 s74, s74, s71
  s_lshl_b32 s74, s74, 14
  s_add_u32 s74, s74, s89
  s_add_u32 m0, s78, 40960
  s_nop 0
  buffer_load_dwordx4 v27, s[32:35], s74 offen lds
  s_add_u32 s74, s3, 16
  s_cmp_ge_u32 s74, s4
  s_cselect_b32 s71, s4, 0
  s_sub_u32 s74, s74, s71
  s_lshl_b32 s74, s74, 14
  s_add_u32 s74, s74, s89
  s_add_u32 m0, s78, 65536
  s_nop 0
  buffer_load_dwordx4 v27, s[32:35], s74 offen lds
  s_mov_b32 s40, s8
  s_and_b32 s41, s9, 0xffff
  s_mov_b32 s42, 2097152
  s_mov_b32 s43, 0x20000
  s_mov_b32 s44, s24
  s_and_b32 s45, s25, 0xffff
  s_mov_b32 s46, 2097152
  s_mov_b32 s47, 0x20000
  v_and_b32 v21, 31, v1
  s_lshl_b32 s69, s86, 5
  v_add_u32 v21, s69, v21
  v_lshlrev_b32 v21, 10, v21
  s_lshl_b32 s69, s85, 7
  s_lshl_b32 s70, s55, 5
  s_add_u32 s69, s69, s70
  v_add_u32 v21, s69, v21
  v_lshrrev_b32 v22, 5, v1
  v_lshlrev_b32 v23, 3, v22
  v_add_u32 v240, v21, v23
  v_lshlrev_b32 v23, 4, v22
  v_add_u32 v241, v21, v23
  buffer_load_dwordx2 v[32:33], v240, s[40:43], 0 offen
  buffer_load_dwordx2 v[34:35], v240, s[40:43], 0 offen offset:16
  v_lshlrev_b32 v242, 4, v1
  s_mul_i32 s69, s86, 86
  s_add_u32 s69, s69, s87
  s_lshl_b32 s98, s69, 10
  s_lshl_b32 s69, s86, 5
  s_lshl_b32 s70, s55, 3
  s_add_u32 s69, s69, s70
  s_lshl_b32 s69, s69, 10
  s_add_u32 s99, s69, 6291456
  s_waitcnt vmcnt(9)
  s_barrier
  s_lshl_b32 s79, s57, 2
  s_add_u32 s79, s79, s61
  s_cmp_eq_u32 s54, 0
  s_cbranch_scc0 L_sig_62
  s_add_u32 s70, s79, 40
  s_lshl_b32 s70, s70, 7
  s_add_u32 s70, s70, 8497152
  v_mov_b32 v31, s70
  v_mov_b32 v30, 1
  s_mov_b64 s[30:31], exec
  s_mov_b64 exec, 1
  buffer_atomic_add v30, v31, s[48:51], 0 offen
  s_mov_b64 exec, s[30:31]
L_sig_62:
  s_add_u32 s74, s3, 17
  s_cmp_ge_u32 s74, s4
  s_cselect_b32 s71, s4, 0
  s_sub_u32 s74, s74, s71
  s_lshl_b32 s74, s74, 14
  s_add_u32 s74, s74, s89
  s_add_u32 m0, s78, 73728
  s_nop 0
  buffer_load_dwordx4 v27, s[32:35], s74 offen lds
  s_add_u32 s74, s3, 18
  s_cmp_ge_u32 s74, s4
  s_cselect_b32 s71, s4, 0
  s_sub_u32 s74, s74, s71
  s_lshl_b32 s74, s74, 14
  s_add_u32 s74, s74, s89
  s_add_u32 m0, s78, 81920
  s_nop 0
  buffer_load_dwordx4 v27, s[32:35], s74 offen lds
  s_add_u32 s74, s3, 19
  s_cmp_ge_u32 s74, s4
  s_cselect_b32 s71, s4, 0
  s_sub_u32 s74, s74, s71
  s_lshl_b32 s74, s74, 14
  s_add_u32 s74, s74, s89
  s_add_u32 m0, s78, 90112
  s_nop 0
  buffer_load_dwordx4 v27, s[32:35], s74 offen lds
  s_add_u32 s74, s3, 20
  s_cmp_ge_u32 s74, s4
  s_cselect_b32 s71, s4, 0
  s_sub_u32 s74, s74, s71
  s_lshl_b32 s74, s74, 14
  s_add_u32 s74, s74, s89
  s_add_u32 m0, s78, 49152
  s_nop 0
  buffer_load_dwordx4 v27, s[32:35], s74 offen lds
  s_add_u32 s74, s3, 21
  s_cmp_ge_u32 s74, s4
  s_cselect_b32 s71, s4, 0
  s_sub_u32 s74, s74, s71
  s_lshl_b32 s74, s74, 14
  s_add_u32 s74, s74, s89
  s_add_u32 m0, s78, 57344
  s_nop 0
  buffer_load_dwordx4 v27, s[32:35], s74 offen lds
  s_add_u32 s74, s5, 0
  s_and_b32 s74, s74, 7
  s_lshl_b32 s74, s74, 14
  s_add_u32 s74, s74, s90
  s_add_u32 m0, s78, 98304
  s_nop 0
  buffer_load_dwordx4 v27, s[36:39], s74 offen lds
  s_add_u32 s74, s5, 1
  s_and_b32 s74, s74, 7
  s_lshl_b32 s74, s74, 14
  s_add_u32 s74, s74, s90
  s_add_u32 m0, s78, 106496
  s_nop 0
  buffer_load_dwordx4 v27, s[36:39], s74 offen lds
  s_add_u32 s74, s5, 2
  s_and_b32 s74, s74, 7
  s_lshl_b32 s74, s74, 14
  s_add_u32 s74, s74, s90
  s_add_u32 m0, s78, 114688
  s_nop 0
  buffer_load_dwordx4 v27, s[36:39], s74 offen lds
  s_add_u32 s74, s5, 3
  s_and_b32 s74, s74, 7
  s_lshl_b32 s74, s74, 14
  s_add_u32 s74, s74, s90
  s_add_u32 m0, s78, 122880
  s_nop 0
  buffer_load_dwordx4 v27, s[36:39], s74 offen lds
  s_add_u32 s74, s5, 4
  s_and_b32 s74, s74, 7
  s_lshl_b32 s74, s74, 14
  s_add_u32 s74, s74, s90
  s_add_u32 m0, s78, 131072
  s_nop 0
  buffer_load_dwordx4 v27, s[36:39], s74 offen lds
  s_add_u32 s74, s5, 5
  s_and_b32 s74, s74, 7
  s_lshl_b32 s74, s74, 14
  s_add_u32 s74, s74, s90
  s_add_u32 m0, s78, 139264
  s_nop 0
  buffer_load_dwordx4 v27, s[36:39], s74 offen lds
  s_add_u32 s74, s5, 6
  s_and_b32 s74, s74, 7
  s_lshl_b32 s74, s74, 14
  s_add_u32 s74, s74, s90
  s_add_u32 m0, s78, 147456
  s_nop 0
  buffer_load_dwordx4 v27, s[36:39], s74 offen lds
  s_add_u32 s74, s5, 7
  s_and_b32 s74, s74, 7
  s_lshl_b32 s74, s74, 14
  s_add_u32 s74, s74, s90
  s_add_u32 m0, s78, 155648
  s_nop 0
  buffer_load_dwordx4 v27, s[36:39], s74 offen lds
  v_mov_b32 v25, 0
  s_mov_b32 s76, 0
  s_mov_b32 s97, 0
  s_branch L_phase2
L_phase2:
  s_lshl_b32 s79, s84, 2
  s_add_u32 s79, s79, s55
  v_readfirstlane_b32 s69, v25
  s_nop 1
  s_cmp_ge_u32 s69, 2
  s_cbranch_scc1 L_wh_63
  s_add_u32 s70, s79, 40
  s_lshl_b32 s70, s70, 7
  s_add_u32 s70, s70, 8497152
  v_mov_b32 v31, s70
  s_mov_b32 s83, 0
  buffer_load_dword v28, v31, s[48:51], 0 offen sc1
  s_sleep 1
  buffer_load_dword v29, v31, s[48:51], 0 offen sc1
  s_sleep 1
  buffer_load_dword v30, v31, s[48:51], 0 offen sc1
L_plh_64:
  s_waitcnt vmcnt(2)
  v_readfirstlane_b32 s69, v28
  s_nop 1
  s_cmp_ge_u32 s69, 2
  s_cbranch_scc1 L_pdh_65
  buffer_load_dword v28, v31, s[48:51], 0 offen sc1
  s_waitcnt vmcnt(2)
  v_readfirstlane_b32 s69, v29
  s_nop 1
  s_cmp_ge_u32 s69, 2
  s_cbranch_scc1 L_pdh_65
  buffer_load_dword v29, v31, s[48:51], 0 offen sc1
  s_waitcnt vmcnt(2)
  v_readfirstlane_b32 s69, v30
  s_nop 1
  s_cmp_ge_u32 s69, 2
  s_cbranch_scc1 L_pdh_65
  buffer_load_dword v30, v31, s[48:51], 0 offen sc1
  s_add_u32 s83, s83, 1
  s_cmp_lt_u32 s83, 32768
  s_cbranch_scc1 L_plh_64
L_pdh_65:
L_wh_63:
  s_add_u32 s69, s3, 0
  s_cmp_ge_u32 s69, s4
  s_cselect_b32 s71, s4, 0
  s_sub_u32 s69, s69, s71
  s_lshl_b32 s69, s69, 10
  s_add_u32 s69, s69, s98
  buffer_load_dwordx4 v[128:131], v242, s[48:51], s69 offen sc1
  s_add_u32 s69, s3, 1
  s_cmp_ge_u32 s69, s4
  s_cselect_b32 s71, s4, 0
  s_sub_u32 s69, s69, s71
  s_lshl_b32 s69, s69, 10
  s_add_u32 s69, s69, s98
  buffer_load_dwordx4 v[132:135], v242, s[48:51], s69 offen sc1
  s_add_u32 s69, s3, 2
  s_cmp_ge_u32 s69, s4
  s_cselect_b32 s71, s4, 0
  s_sub_u32 s69, s69, s71
  s_lshl_b32 s69, s69, 10
  s_add_u32 s69, s69, s98
  buffer_load_dwordx4 v[136:139], v242, s[48:51], s69 offen sc1
  s_add_u32 s69, s3, 3
  s_cmp_ge_u32 s69, s4
  s_cselect_b32 s71, s4, 0
  s_sub_u32 s69, s69, s71
  s_lshl_b32 s69, s69, 10
  s_add_u32 s69, s69, s98
  buffer_load_dwordx4 v[140:143], v242, s[48:51], s69 offen sc1
  s_add_u32 s69, s3, 4
  s_cmp_ge_u32 s69, s4
  s_cselect_b32 s71, s4, 0
  s_sub_u32 s69, s69, s71
  s_lshl_b32 s69, s69, 10
  s_add_u32 s69, s69, s98
  buffer_load_dwordx4 v[144:147], v242, s[48:51], s69 offen sc1
  s_add_u32 s69, s3, 5
  s_cmp_ge_u32 s69, s4
  s_cselect_b32 s71, s4, 0
  s_sub_u32 s69, s69, s71
  s_lshl_b32 s69, s69, 10
  s_add_u32 s69, s69, s98
  buffer_load_dwordx4 v[148:151], v242, s[48:51], s69 offen sc1
  s_add_u32 s69, s3, 6
  s_cmp_ge_u32 s69, s4
  s_cselect_b32 s71, s4, 0
  s_sub_u32 s69, s69, s71
  s_lshl_b32 s69, s69, 10
  s_add_u32 s69, s69, s98
  buffer_load_dwordx4 v[152:155], v242, s[48:51], s69 offen sc1
  s_add_u32 s69, s3, 7
  s_cmp_ge_u32 s69, s4
  s_cselect_b32 s71, s4, 0
  s_sub_u32 s69, s69, s71
  s_lshl_b32 s69, s69, 10
  s_add_u32 s69, s69, s98
  buffer_load_dwordx4 v[156:159], v242, s[48:51], s69 offen sc1
  s_add_u32 s69, s3, 8
  s_cmp_ge_u32 s69, s4
  s_cselect_b32 s71, s4, 0
  s_sub_u32 s69, s69, s71
  s_lshl_b32 s69, s69, 10
  s_add_u32 s69, s69, s98
  buffer_load_dwordx4 v[224:227], v242, s[48:51], s69 offen sc1
  s_add_u32 s69, s3, 9
  s_cmp_ge_u32 s69, s4
  s_cselect_b32 s71, s4, 0
  s_sub_u32 s69, s69, s71
  s_lshl_b32 s69, s69, 10
  s_add_u32 s69, s69, s98
  buffer_load_dwordx4 v[228:231], v242, s[48:51], s69 offen sc1
  s_add_u32 s69, s3, 10
  s_cmp_ge_u32 s69, s4
  s_cselect_b32 s71, s4, 0
  s_sub_u32 s69, s69, s71
  s_lshl_b32 s69, s69, 10
  s_add_u32 s69, s69, s98
  buffer_load_dwordx4 v[232:235], v242, s[48:51], s69 offen sc1
  s_add_u32 s69, s3, 11
  s_cmp_ge_u32 s69, s4
  s_cselect_b32 s71, s4, 0
  s_sub_u32 s69, s69, s71
  s_lshl_b32 s69, s69, 10
  s_add_u32 s69, s69, s98
  buffer_load_dwordx4 v[236:239], v242, s[48:51], s69 offen sc1
  s_waitcnt vmcnt(12)
  s_barrier
  s_cmp_eq_u32 s97, 1
  s_cbranch_scc0 L_pend_66
  s_lshl_b32 s72, s57, 2
  s_add_u32 s72, s72, s61
  s_cmp_eq_u32 s54, 0
  s_cbranch_scc0 L_sig_67
  s_add_u32 s70, s72, 104
  s_lshl_b32 s70, s70, 7
  s_add_u32 s70, s70, 8497152
  v_mov_b32 v29, s70
  v_mov_b32 v28, 1
  s_mov_b64 s[30:31], exec
  s_mov_b64 exec, 1
  buffer_atomic_add v28, v29, s[48:51], 0 offen
  s_mov_b64 exec, s[30:31]
L_sig_67:
L_pend_66:
  s_waitcnt vmcnt(11)
  v_mfma_f32_32x32x16_bf16 v[96:111], v[40:43], v[128:131], 0
  v_mfma_f32_32x32x16_bf16 v[112:127], v[44:47], v[128:131], 0
  s_add_u32 s69, s3, 12
  s_cmp_ge_u32 s69, s4
  s_cselect_b32 s71, s4, 0
  s_sub_u32 s69, s69, s71
  s_lshl_b32 s69, s69, 10
  s_add_u32 s69, s69, s98
  buffer_load_dwordx4 v[128:131], v242, s[48:51], s69 offen sc1
  s_waitcnt vmcnt(11)
  v_mfma_f32_32x32x16_bf16 v[96:111], v[48:51], v[132:135], v[96:111]
  v_mfma_f32_32x32x16_bf16 v[112:127], v[52:55], v[132:135], v[112:127]
  s_add_u32 s69, s3, 13
  s_cmp_ge_u32 s69, s4
  s_cselect_b32 s71, s4, 0
  s_sub_u32 s69, s69, s71
  s_lshl_b32 s69, s69, 10
  s_add_u32 s69, s69, s98
  buffer_load_dwordx4 v[132:135], v242, s[48:51], s69 offen sc1
  s_waitcnt vmcnt(11)
  v_mfma_f32_32x32x16_bf16 v[96:111], v[56:59], v[136:139], v[96:111]
  v_mfma_f32_32x32x16_bf16 v[112:127], v[60:63], v[136:139], v[112:127]
  s_add_u32 s69, s3, 14
  s_cmp_ge_u32 s69, s4
  s_cselect_b32 s71, s4, 0
  s_sub_u32 s69, s69, s71
  s_lshl_b32 s69, s69, 10
  s_add_u32 s69, s69, s98
  buffer_load_dwordx4 v[136:139], v242, s[48:51], s69 offen sc1
  s_waitcnt vmcnt(11)
  v_mfma_f32_32x32x16_bf16 v[96:111], v[64:67], v[140:143], v[96:111]
  v_mfma_f32_32x32x16_bf16 v[112:127], v[68:71], v[140:143], v[112:127]
  s_add_u32 s69, s3, 15
  s_cmp_ge_u32 s69, s4
  s_cselect_b32 s71, s4, 0
  s_sub_u32 s69, s69, s71
  s_lshl_b32 s69, s69, 10
  s_add_u32 s69, s69, s98
  buffer_load_dwordx4 v[140:143], v242, s[48:51], s69 offen sc1
  s_waitcnt vmcnt(11)
  v_mfma_f32_32x32x16_bf16 v[96:111], v[72:75], v[144:147], v[96:111]
  v_mfma_f32_32x32x16_bf16 v[112:127], v[76:79], v[144:147], v[112:127]
  s_add_u32 s69, s3, 16
  s_cmp_ge_u32 s69, s4
  s_cselect_b32 s71, s4, 0
  s_sub_u32 s69, s69, s71
  s_lshl_b32 s69, s69, 10
  s_add_u32 s69, s69, s98
  buffer_load_dwordx4 v[144:147], v242, s[48:51], s69 offen sc1
  s_waitcnt vmcnt(11)
  v_mfma_f32_32x32x16_bf16 v[96:111], v[80:83], v[148:151], v[96:111]
  v_mfma_f32_32x32x16_bf16 v[112:127], v[84:87], v[148:151], v[112:127]
  s_add_u32 s69, s3, 17
  s_cmp_ge_u32 s69, s4
  s_cselect_b32 s71, s4, 0
  s_sub_u32 s69, s69, s71
  s_lshl_b32 s69, s69, 10
  s_add_u32 s69, s69, s98
  buffer_load_dwordx4 v[148:151], v242, s[48:51], s69 offen sc1
  s_waitcnt vmcnt(11)
  v_mfma_f32_32x32x16_bf16 v[96:111], v[192:195], v[152:155], v[96:111]
  v_mfma_f32_32x32x16_bf16 v[112:127], v[196:199], v[152:155], v[112:127]
  s_add_u32 s69, s3, 18
  s_cmp_ge_u32 s69, s4
  s_cselect_b32 s71, s4, 0
  s_sub_u32 s69, s69, s71
  s_lshl_b32 s69, s69, 10
  s_add_u32 s69, s69, s98
  buffer_load_dwordx4 v[152:155], v242, s[48:51], s69 offen sc1
  s_waitcnt vmcnt(11)
  v_mfma_f32_32x32x16_bf16 v[96:111], v[200:203], v[156:159], v[96:111]
  v_mfma_f32_32x32x16_bf16 v[112:127], v[204:207], v[156:159], v[112:127]
  s_add_u32 s69, s3, 19
  s_cmp_ge_u32 s69, s4
  s_cselect_b32 s71, s4, 0
  s_sub_u32 s69, s69, s71
  s_lshl_b32 s69, s69, 10
  s_add_u32 s69, s69, s98
  buffer_load_dwordx4 v[156:159], v242, s[48:51], s69 offen sc1
  s_waitcnt vmcnt(11)
  v_mfma_f32_32x32x16_bf16 v[96:111], v[208:211], v[224:227], v[96:111]
  v_mfma_f32_32x32x16_bf16 v[112:127], v[212:215], v[224:227], v[112:127]
  s_add_u32 s69, s3, 20
  s_cmp_ge_u32 s69, s4
  s_cselect_b32 s71, s4, 0
  s_sub_u32 s69, s69, s71
  s_lshl_b32 s69, s69, 10
  s_add_u32 s69, s69, s98
  buffer_load_dwordx4 v[224:227], v242, s[48:51], s69 offen sc1
  s_waitcnt vmcnt(11)
  v_mfma_f32_32x32x16_bf16 v[96:111], v[216:219], v[228:231], v[96:111]
  v_mfma_f32_32x32x16_bf16 v[112:127], v[220:223], v[228:231], v[112:127]
  s_add_u32 s69, s3, 21
  s_cmp_ge_u32 s69, s4
  s_cselect_b32 s71, s4, 0
  s_sub_u32 s69, s69, s71
  s_lshl_b32 s69, s69, 10
  s_add_u32 s69, s69, s98
  buffer_load_dwordx4 v[228:231], v242, s[48:51], s69 offen sc1
  s_add_u32 s70, s79, 104
  s_lshl_b32 s70, s70, 7
  s_add_u32 s70, s70, 8497152
  v_mov_b32 v31, s70
  buffer_load_dword v30, v31, s[48:51], 0 offen sc1
  s_barrier
  ds_read_b64_tr_b16 v[160:161], v12 offset:0
  ds_read_b64_tr_b16 v[162:163], v12 offset:1024
  ds_read_b64_tr_b16 v[164:165], v13 offset:0
  ds_read_b64_tr_b16 v[166:167], v13 offset:1024
  ds_read_b64_tr_b16 v[168:169], v12 offset:8192
  ds_read_b64_tr_b16 v[170:171], v12 offset:9216
  ds_read_b64_tr_b16 v[172:173], v13 offset:8192
  ds_read_b64_tr_b16 v[174:175], v13 offset:9216
  ds_read_b64_tr_b16 v[176:177], v12 offset:16384
  ds_read_b64_tr_b16 v[178:179], v12 offset:17408
  ds_read_b64_tr_b16 v[180:181], v13 offset:16384
  ds_read_b64_tr_b16 v[182:183], v13 offset:17408
  ds_read_b64_tr_b16 v[184:185], v12 offset:24576
  ds_read_b64_tr_b16 v[186:187], v12 offset:25600
  ds_read_b64_tr_b16 v[188:189], v13 offset:24576
  ds_read_b64_tr_b16 v[190:191], v13 offset:25600
  s_waitcnt vmcnt(12)
  s_waitcnt lgkmcnt(12)
  v_mfma_f32_32x32x16_bf16 v[96:111], v[160:163], v[232:235], v[96:111]
  v_mfma_f32_32x32x16_bf16 v[112:127], v[164:167], v[232:235], v[112:127]
  ds_read_b64_tr_b16 v[160:161], v12 offset:32768
  ds_read_b64_tr_b16 v[162:163], v12 offset:33792
  ds_read_b64_tr_b16 v[164:165], v13 offset:32768
  ds_read_b64_tr_b16 v[166:167], v13 offset:33792
  s_waitcnt vmcnt(11)
  s_waitcnt lgkmcnt(12)
  v_mfma_f32_32x32x16_bf16 v[96:111], v[168:171], v[236:239], v[96:111]
  v_mfma_f32_32x32x16_bf16 v[112:127], v[172:175], v[236:239], v[112:127]
  ds_read_b64_tr_b16 v[168:169], v12 offset:40960
  ds_read_b64_tr_b16 v[170:171], v12 offset:41984
  ds_read_b64_tr_b16 v[172:173], v13 offset:40960
  ds_read_b64_tr_b16 v[174:175], v13 offset:41984
  s_waitcnt vmcnt(10)
  s_waitcnt lgkmcnt(12)
  v_mfma_f32_32x32x16_bf16 v[96:111], v[176:179], v[128:131], v[96:111]
  v_mfma_f32_32x32x16_bf16 v[112:127], v[180:183], v[128:131], v[112:127]
  ds_read_b64_tr_b16 v[176:177], v14 offset:0
  ds_read_b64_tr_b16 v[178:179], v14 offset:1024
  ds_read_b64_tr_b16 v[180:181], v15 offset:0
  ds_read_b64_tr_b16 v[182:183], v15 offset:1024
  s_waitcnt vmcnt(9)
  s_waitcnt lgkmcnt(12)
  v_mfma_f32_32x32x16_bf16 v[96:111], v[184:187], v[132:135], v[96:111]
  v_mfma_f32_32x32x16_bf16 v[112:127], v[188:191], v[132:135], v[112:127]
  ds_read_b64_tr_b16 v[184:185], v14 offset:8192
  ds_read_b64_tr_b16 v[186:187], v14 offset:9216
  ds_read_b64_tr_b16 v[188:189], v15 offset:8192
  ds_read_b64_tr_b16 v[190:191], v15 offset:9216
  s_waitcnt vmcnt(8)
  s_waitcnt lgkmcnt(12)
  v_mfma_f32_32x32x16_bf16 v[96:111], v[160:163], v[136:139], v[96:111]
  v_mfma_f32_32x32x16_bf16 v[112:127], v[164:167], v[136:139], v[112:127]
  s_waitcnt vmcnt(0)
  v_readfirstlane_b32 s69, v30
  s_nop 1
  s_cmp_ge_u32 s69, 2
  s_cbranch_scc1 L_ook_68
  s_mov_b32 s83, 0
  buffer_load_dword v28, v31, s[48:51], 0 offen sc1
  s_sleep 1
  buffer_load_dword v29, v31, s[48:51], 0 offen sc1
  s_sleep 1
  buffer_load_dword v30, v31, s[48:51], 0 offen sc1
L_plo_69:
  s_waitcnt vmcnt(2)
  v_readfirstlane_b32 s69, v28
  s_nop 1
  s_cmp_ge_u32 s69, 2
  s_cbranch_scc1 L_pdo_70
  buffer_load_dword v28, v31, s[48:51], 0 offen sc1
  s_waitcnt vmcnt(2)
  v_readfirstlane_b32 s69, v29
  s_nop 1
  s_cmp_ge_u32 s69, 2
  s_cbranch_scc1 L_pdo_70
  buffer_load_dword v29, v31, s[48:51], 0 offen sc1
  s_waitcnt vmcnt(2)
  v_readfirstlane_b32 s69, v30
  s_nop 1
  s_cmp_ge_u32 s69, 2
  s_cbranch_scc1 L_pdo_70
  buffer_load_dword v30, v31, s[48:51], 0 offen sc1
  s_add_u32 s83, s83, 1
  s_cmp_lt_u32 s83, 32768
  s_cbranch_scc1 L_plo_69
L_pdo_70:
L_ook_68:
  s_add_u32 s69, s5, 0
  s_and_b32 s69, s69, 7
  s_lshl_b32 s69, s69, 10
  s_add_u32 s69, s69, s99
  buffer_load_dwordx4 v[232:235], v242, s[48:51], s69 offen sc1
  s_add_u32 s69, s5, 1
  s_and_b32 s69, s69, 7
  s_lshl_b32 s69, s69, 10
  s_add_u32 s69, s69, s99
  buffer_load_dwordx4 v[236:239], v242, s[48:51], s69 offen sc1
  s_add_u32 s69, s5, 2
  s_and_b32 s69, s69, 7
  s_lshl_b32 s69, s69, 10
  s_add_u32 s69, s69, s99
  buffer_load_dwordx4 v[128:131], v242, s[48:51], s69 offen sc1
  s_add_u32 s69, s5, 3
  s_and_b32 s69, s69, 7
  s_lshl_b32 s69, s69, 10
  s_add_u32 s69, s69, s99
  buffer_load_dwordx4 v[132:135], v242, s[48:51], s69 offen sc1
  s_add_u32 s69, s5, 4
  s_and_b32 s69, s69, 7
  s_lshl_b32 s69, s69, 10
  s_add_u32 s69, s69, s99
  buffer_load_dwordx4 v[136:139], v242, s[48:51], s69 offen sc1
  ds_read_b64_tr_b16 v[160:161], v14 offset:16384
  ds_read_b64_tr_b16 v[162:163], v14 offset:17408
  ds_read_b64_tr_b16 v[164:165], v15 offset:16384
  ds_read_b64_tr_b16 v[166:167], v15 offset:17408
  s_waitcnt vmcnt(12)
  s_waitcnt lgkmcnt(12)
  v_mfma_f32_32x32x16_bf16 v[96:111], v[168:171], v[140:143], v[96:111]
  v_mfma_f32_32x32x16_bf16 v[112:127], v[172:175], v[140:143], v[112:127]
  s_add_u32 s69, s5, 5
  s_and_b32 s69, s69, 7
  s_lshl_b32 s69, s69, 10
  s_add_u32 s69, s69, s99
  buffer_load_dwordx4 v[140:143], v242, s[48:51], s69 offen sc1
  ds_read_b64_tr_b16 v[168:169], v14 offset:24576
  ds_read_b64_tr_b16 v[170:171], v14 offset:25600
  ds_read_b64_tr_b16 v[172:173], v15 offset:24576
  ds_read_b64_tr_b16 v[174:175], v15 offset:25600
  s_waitcnt vmcnt(12)
  s_waitcnt lgkmcnt(12)
  v_mfma_f32_32x32x16_bf16 v[96:111], v[176:179], v[144:147], v[96:111]
  v_mfma_f32_32x32x16_bf16 v[112:127], v[180:183], v[144:147], v[112:127]
  s_add_u32 s69, s5, 6
  s_and_b32 s69, s69, 7
  s_lshl_b32 s69, s69, 10
  s_add_u32 s69, s69, s99
  buffer_load_dwordx4 v[144:147], v242, s[48:51], s69 offen sc1
  ds_read_b64_tr_b16 v[176:177], v12 offset:49152
  ds_read_b64_tr_b16 v[178:179], v12 offset:50176
  ds_read_b64_tr_b16 v[180:181], v13 offset:49152
  ds_read_b64_tr_b16 v[182:183], v13 offset:50176
  s_waitcnt vmcnt(12)
  s_waitcnt lgkmcnt(12)
  v_mfma_f32_32x32x16_bf16 v[96:111], v[184:187], v[148:151], v[96:111]
  v_mfma_f32_32x32x16_bf16 v[112:127], v[188:191], v[148:151], v[112:127]
  s_add_u32 s69, s5, 7
  s_and_b32 s69, s69, 7
  s_lshl_b32 s69, s69, 10
  s_add_u32 s69, s69, s99
  buffer_load_dwordx4 v[148:151], v242, s[48:51], s69 offen sc1
  ds_read_b64_tr_b16 v[184:185], v12 offset:57344
  ds_read_b64_tr_b16 v[186:187], v12 offset:58368
  ds_read_b64_tr_b16 v[188:189], v13 offset:57344
  ds_read_b64_tr_b16 v[190:191], v13 offset:58368
  s_waitcnt vmcnt(12)
  s_waitcnt lgkmcnt(12)
  v_mfma_f32_32x32x16_bf16 v[96:111], v[160:163], v[152:155], v[96:111]
  v_mfma_f32_32x32x16_bf16 v[112:127], v[164:167], v[152:155], v[112:127]
  ds_read_b64_tr_b16 v[160:161], v14 offset:32768
  ds_read_b64_tr_b16 v[162:163], v14 offset:33792
  ds_read_b64_tr_b16 v[164:165], v15 offset:32768
  ds_read_b64_tr_b16 v[166:167], v15 offset:33792
  s_waitcnt vmcnt(11)
  s_waitcnt lgkmcnt(12)
  v_mfma_f32_32x32x16_bf16 v[96:111], v[168:171], v[156:159], v[96:111]
  v_mfma_f32_32x32x16_bf16 v[112:127], v[172:175], v[156:159], v[112:127]
  ds_read_b64_tr_b16 v[168:169], v14 offset:40960
  ds_read_b64_tr_b16 v[170:171], v14 offset:41984
  ds_read_b64_tr_b16 v[172:173], v15 offset:40960
  ds_read_b64_tr_b16 v[174:175], v15 offset:41984
  s_waitcnt vmcnt(10)
  s_waitcnt lgkmcnt(12)
  v_mfma_f32_32x32x16_bf16 v[96:111], v[176:179], v[224:227], v[96:111]
  v_mfma_f32_32x32x16_bf16 v[112:127], v[180:183], v[224:227], v[112:127]
  ds_read_b64_tr_b16 v[176:177], v14 offset:49152
  ds_read_b64_tr_b16 v[178:179], v14 offset:50176
  ds_read_b64_tr_b16 v[180:181], v15 offset:49152
  ds_read_b64_tr_b16 v[182:183], v15 offset:50176
  s_cmp_ge_u32 s55, 2
  s_cbranch_scc1 L_p2skip_71
  s_waitcnt vmcnt(9)
  s_waitcnt lgkmcnt(12)
  v_mfma_f32_32x32x16_bf16 v[96:111], v[184:187], v[228:231], v[96:111]
  v_mfma_f32_32x32x16_bf16 v[112:127], v[188:191], v[228:231], v[112:127]
L_p2skip_71:
  ds_read_b64_tr_b16 v[184:185], v14 offset:57344
  ds_read_b64_tr_b16 v[186:187], v14 offset:58368
  ds_read_b64_tr_b16 v[188:189], v15 offset:57344
  ds_read_b64_tr_b16 v[190:191], v15 offset:58368
  s_waitcnt vmcnt(7)
  s_waitcnt lgkmcnt(12)
  v_mfma_f32_32x32x16_bf16 v[96:111], v[160:163], v[232:235], v[96:111]
  v_mfma_f32_32x32x16_bf16 v[112:127], v[164:167], v[232:235], v[112:127]
  ds_read_b64_tr_b16 v[160:161], v18 offset:0
  ds_read_b64_tr_b16 v[162:163], v18 offset:1024
  ds_read_b64_tr_b16 v[164:165], v19 offset:0
  ds_read_b64_tr_b16 v[166:167], v19 offset:1024
  s_waitcnt vmcnt(6)
  s_waitcnt lgkmcnt(12)
  v_mfma_f32_32x32x16_bf16 v[96:111], v[168:171], v[236:239], v[96:111]
  v_mfma_f32_32x32x16_bf16 v[112:127], v[172:175], v[236:239], v[112:127]
  ds_read_b64_tr_b16 v[168:169], v18 offset:8192
  ds_read_b64_tr_b16 v[170:171], v18 offset:9216
  ds_read_b64_tr_b16 v[172:173], v19 offset:8192
  ds_read_b64_tr_b16 v[174:175], v19 offset:9216
  s_waitcnt vmcnt(5)
  s_waitcnt lgkmcnt(12)
  v_mfma_f32_32x32x16_bf16 v[96:111], v[176:179], v[128:131], v[96:111]
  v_mfma_f32_32x32x16_bf16 v[112:127], v[180:183], v[128:131], v[112:127]
  ds_read_b64_tr_b16 v[176:177], v18 offset:16384
  ds_read_b64_tr_b16 v[178:179], v18 offset:17408
  ds_read_b64_tr_b16 v[180:181], v19 offset:16384
  ds_read_b64_tr_b16 v[182:183], v19 offset:17408
  s_waitcnt vmcnt(4)
  s_waitcnt lgkmcnt(12)
  v_mfma_f32_32x32x16_bf16 v[96:111], v[184:187], v[132:135], v[96:111]
  v_mfma_f32_32x32x16_bf16 v[112:127], v[188:191], v[132:135], v[112:127]
  ds_read_b64_tr_b16 v[184:185], v18 offset:24576
  ds_read_b64_tr_b16 v[186:187], v18 offset:25600
  ds_read_b64_tr_b16 v[188:189], v19 offset:24576
  ds_read_b64_tr_b16 v[190:191], v19 offset:25600
  s_waitcnt vmcnt(3)
  s_waitcnt lgkmcnt(12)
  v_mfma_f32_32x32x16_bf16 v[96:111], v[160:163], v[136:139], v[96:111]
  v_mfma_f32_32x32x16_bf16 v[112:127], v[164:167], v[136:139], v[112:127]
  s_waitcnt vmcnt(2)
  s_waitcnt lgkmcnt(8)
  v_mfma_f32_32x32x16_bf16 v[96:111], v[168:171], v[140:143], v[96:111]
  v_mfma_f32_32x32x16_bf16 v[112:127], v[172:175], v[140:143], v[112:127]
  s_waitcnt vmcnt(1)
  s_waitcnt lgkmcnt(4)
  v_mfma_f32_32x32x16_bf16 v[96:111], v[176:179], v[144:147], v[96:111]
  v_mfma_f32_32x32x16_bf16 v[112:127], v[180:183], v[144:147], v[112:127]
  s_waitcnt vmcnt(0)
  s_waitcnt lgkmcnt(0)
  v_mfma_f32_32x32x16_bf16 v[96:111], v[184:187], v[148:151], v[96:111]
  v_mfma_f32_32x32x16_bf16 v[112:127], v[188:191], v[148:151], v[112:127]
  s_barrier
  v_lshlrev_b32 v243, 4, v1
  s_mul_i32 s69, s56, 24576
  v_add_u32 v243, s69, v243
  s_mul_i32 s70, s55, 6144
  v_add_u32 v244, s70, v243
  s_cmp_eq_u32 s55, 0
  s_cbranch_scc0 L_redq_74
  s_nop 2
  ds_write_b128 v243, v[104:107] offset:10240
  ds_write_b128 v243, v[108:111] offset:11264
  ds_write_b128 v243, v[112:115] offset:14336
  ds_write_b128 v243, v[116:119] offset:15360
  ds_write_b128 v243, v[120:123] offset:18432
  ds_write_b128 v243, v[124:127] offset:19456
  v_lshlrev_b32 v160, 16, v32
  v_and_b32 v161, 0xffff0000, v32
  v_lshlrev_b32 v162, 16, v33
  v_and_b32 v163, 0xffff0000, v33
  v_lshlrev_b32 v164, 16, v34
  v_and_b32 v165, 0xffff0000, v34
  v_lshlrev_b32 v166, 16, v35
  v_and_b32 v167, 0xffff0000, v35
  v_add_f32 v160, v160, v96
  v_add_f32 v161, v161, v97
  v_add_f32 v162, v162, v98
  v_add_f32 v163, v163, v99
  v_add_f32 v164, v164, v100
  v_add_f32 v165, v165, v101
  v_add_f32 v166, v166, v102
  v_add_f32 v167, v167, v103
  s_branch L_redw_72
L_redq_74:
  s_cmp_eq_u32 s55, 1
  s_cbranch_scc0 L_redq_75
  s_nop 0
  ds_write_b128 v243, v[96:99] offset:0
  ds_write_b128 v243, v[100:103] offset:1024
  ds_write_b128 v243, v[112:115] offset:16384
  ds_write_b128 v243, v[116:119] offset:17408
  ds_write_b128 v243, v[120:123] offset:20480
  ds_write_b128 v243, v[124:127] offset:21504
  v_lshlrev_b32 v160, 16, v32
  v_and_b32 v161, 0xffff0000, v32
  v_lshlrev_b32 v162, 16, v33
  v_and_b32 v163, 0xffff0000, v33
  v_lshlrev_b32 v164, 16, v34
  v_and_b32 v165, 0xffff0000, v34
  v_lshlrev_b32 v166, 16, v35
  v_and_b32 v167, 0xffff0000, v35
  v_add_f32 v160, v160, v104
  v_add_f32 v161, v161, v105
  v_add_f32 v162, v162, v106
  v_add_f32 v163, v163, v107
  v_add_f32 v164, v164, v108
  v_add_f32 v165, v165, v109
  v_add_f32 v166, v166, v110
  v_add_f32 v167, v167, v111
  s_branch L_redw_72
L_redq_75:
  s_cmp_eq_u32 s55, 2
  s_cbranch_scc0 L_redq_76
  ds_write_b128 v243, v[96:99] offset:2048
  ds_write_b128 v243, v[100:103] offset:3072
  ds_write_b128 v243, v[104:107] offset:6144
  ds_write_b128 v243, v[108:111] offset:7168
  ds_write_b128 v243, v[120:123] offset:22528
  ds_write_b128 v243, v[124:127] offset:23552
  v_lshlrev_b32 v160, 16, v32
  v_and_b32 v161, 0xffff0000, v32
  v_lshlrev_b32 v162, 16, v33
  v_and_b32 v163, 0xffff0000, v33
  v_lshlrev_b32 v164, 16, v34
  v_and_b32 v165, 0xffff0000, v34
  v_lshlrev_b32 v166, 16, v35
  v_and_b32 v167, 0xffff0000, v35
  v_add_f32 v160, v160, v112
  v_add_f32 v161, v161, v113
  v_add_f32 v162, v162, v114
  v_add_f32 v163, v163, v115
  v_add_f32 v164, v164, v116
  v_add_f32 v165, v165, v117
  v_add_f32 v166, v166, v118
  v_add_f32 v167, v167, v119
  s_branch L_redw_72
L_redq_76:
  ds_write_b128 v243, v[96:99] offset:4096
  ds_write_b128 v243, v[100:103] offset:5120
  ds_write_b128 v243, v[104:107] offset:8192
  ds_write_b128 v243, v[108:111] offset:9216
  ds_write_b128 v243, v[112:115] offset:12288
  ds_write_b128 v243, v[116:119] offset:13312
  v_lshlrev_b32 v160, 16, v32
  v_and_b32 v161, 0xffff0000, v32
  v_lshlrev_b32 v162, 16, v33
  v_and_b32 v163, 0xffff0000, v33
  v_lshlrev_b32 v164, 16, v34
  v_and_b32 v165, 0xffff0000, v34
  v_lshlrev_b32 v166, 16, v35
  v_and_b32 v167, 0xffff0000, v35
  v_add_f32 v160, v160, v120
  v_add_f32 v161, v161, v121
  v_add_f32 v162, v162, v122
  v_add_f32 v163, v163, v123
  v_add_f32 v164, v164, v124
  v_add_f32 v165, v165, v125
  v_add_f32 v166, v166, v126
  v_add_f32 v167, v167, v127
L_redw_72:
  s_waitcnt lgkmcnt(0)
  s_barrier
  ds_read_b128 v[40:43], v244 offset:0
  ds_read_b128 v[44:47], v244 offset:1024
  ds_read_b128 v[48:51], v244 offset:2048
  ds_read_b128 v[52:55], v244 offset:3072
  ds_read_b128 v[56:59], v244 offset:4096
  ds_read_b128 v[60:63], v244 offset:5120
  s_waitcnt lgkmcnt(4)
  v_add_f32 v160, v160, v40
  v_add_f32 v161, v161, v41
  v_add_f32 v162, v162, v42
  v_add_f32 v163, v163, v43
  v_add_f32 v164, v164, v44
  v_add_f32 v165, v165, v45
  v_add_f32 v166, v166, v46
  v_add_f32 v167, v167, v47
  s_waitcnt lgkmcnt(2)
  v_add_f32 v160, v160, v48
  v_add_f32 v161, v161, v49
  v_add_f32 v162, v162, v50
  v_add_f32 v163, v163, v51
  v_add_f32 v164, v164, v52
  v_add_f32 v165, v165, v53
  v_add_f32 v166, v166, v54
  v_add_f32 v167, v167, v55
  s_waitcnt lgkmcnt(0)
  v_add_f32 v160, v160, v56
  v_add_f32 v161, v161, v57
  v_add_f32 v162, v162, v58
  v_add_f32 v163, v163, v59
  v_add_f32 v164, v164, v60
  v_add_f32 v165, v165, v61
  v_add_f32 v166, v166, v62
  v_add_f32 v167, v167, v63
  v_cvt_pk_bf16_f32 v128, v160, v161
  v_cvt_pk_bf16_f32 v129, v162, v163
  v_cvt_pk_bf16_f32 v130, v164, v165
  v_cvt_pk_bf16_f32 v131, v166, v167
  s_nop 0
  v_permlane32_swap_b32 v128, v130
  v_permlane32_swap_b32 v129, v131
  buffer_store_dwordx4 v[128:131], v241, s[44:47], 0 offen
  s_branch L_end
L_slow_ini_a:
  s_mov_b32 s83, 0
L_spinini_a_77:
  global_load_dword v25, v2, s[26:27] sc1
  s_waitcnt vmcnt(0)
  v_readfirstlane_b32 s69, v25
  s_nop 1
  s_cmp_ge_u32 s69, 32
  s_cbranch_scc1 L_spunini_a_78
  s_add_u32 s83, s83, 1
  s_cmp_ge_u32 s83, 32768
  s_cbranch_scc1 L_spunini_a_78
  s_sleep 2
  s_branch L_spinini_a_77
L_spunini_a_78:
  s_branch L_back_ini_a
L_slow_cs_a:
  s_mov_b32 s83, 0
L_spincs_a_79:
  buffer_load_dword v25, v2, s[48:51], s91 offen sc1
  s_waitcnt vmcnt(0)
  v_readfirstlane_b32 s69, v25
  s_nop 1
  s_cmp_ge_u32 s69, 16
  s_cbranch_scc1 L_spuncs_a_80
  s_add_u32 s83, s83, 1
  s_cmp_ge_u32 s83, 32768
  s_cbranch_scc1 L_spuncs_a_80
  s_sleep 2
  s_branch L_spincs_a_79
L_spuncs_a_80:
  s_branch L_back_cs_a
L_slow_st_a:
  s_mov_b32 s83, 0
L_spinst_a_81:
  buffer_load_dword v20, v2, s[48:51], s92 offen sc1
  s_waitcnt vmcnt(0)
  v_readfirstlane_b32 s69, v20
  s_nop 1
  s_cmp_ge_u32 s69, 8
  s_cbranch_scc1 L_spunst_a_82
  s_add_u32 s83, s83, 1
  s_cmp_ge_u32 s83, 32768
  s_cbranch_scc1 L_spunst_a_82
  s_sleep 2
  s_branch L_spinst_a_81
L_spunst_a_82:
  s_branch L_back_st_a
L_slow_ini_f:
  s_mov_b32 s83, 0
L_spinini_f_83:
  global_load_dword v25, v2, s[26:27] sc1
  s_waitcnt vmcnt(0)
  v_readfirstlane_b32 s69, v25
  s_nop 1
  s_cmp_ge_u32 s69, 32
  s_cbranch_scc1 L_spunini_f_84
  s_add_u32 s83, s83, 1
  s_cmp_ge_u32 s83, 32768
  s_cbranch_scc1 L_spunini_f_84
  s_sleep 2
  s_branch L_spinini_f_83
L_spunini_f_84:
  s_branch L_back_ini_f
L_slow_cs_f:
  s_mov_b32 s83, 0
L_spincs_f_85:
  buffer_load_dword v25, v249, s[48:51], 0 offen sc1
  s_waitcnt vmcnt(0)
  v_readfirstlane_b32 s69, v25
  s_nop 1
  s_cmp_ge_u32 s69, 16
  s_cbranch_scc1 L_spuncs_f_86
  s_add_u32 s83, s83, 1
  s_cmp_ge_u32 s83, 32768
  s_cbranch_scc1 L_spuncs_f_86
  s_sleep 2
  s_branch L_spincs_f_85
L_spuncs_f_86:
  s_branch L_back_cs_f
L_slow_st_f:
  s_mov_b32 s83, 0
L_spinst_f_87:
  buffer_load_dword v20, v250, s[48:51], 0 offen sc1
  s_waitcnt vmcnt(0)
  v_readfirstlane_b32 s69, v20
  s_nop 1
  s_cmp_ge_u32 s69, 8
  s_cbranch_scc1 L_spunst_f_88
  s_add_u32 s83, s83, 1
  s_cmp_ge_u32 s83, 32768
  s_cbranch_scc1 L_spunst_f_88
  s_sleep 2
  s_branch L_spinst_f_87
L_spunst_f_88:
  s_branch L_back_st_f
L_end:
  s_endpgm
L_code_end:
.section .rodata,"a"
.p2align 6
.amdhsa_kernel parallel_sum__linear_kernel_hedgehog__glu_gated_reglu__prompt_kernel
  .amdhsa_next_free_vgpr 256
  .amdhsa_next_free_sgpr 102
  .amdhsa_accum_offset 256
  .amdhsa_group_segment_fixed_size 0
  .amdhsa_kernarg_size 88
  .amdhsa_user_sgpr_count 2
  .amdhsa_user_sgpr_kernarg_segment_ptr 1
  .amdhsa_system_sgpr_workgroup_id_x 1
.end_amdhsa_kernel
```
